```python
import torch

def _softmax(x, axis=-1):
    return torch.softmax(x, dim=axis)
def _gelu(x):
    return torch.nn.functional.gelu(x, approximate="tanh")
def _silu(x):
    return torch.nn.functional.silu(x)
def _sigmoid(x):
    return torch.sigmoid(x)
def _layernorm(x, axis=-1, eps=1e-5):
    m = x.mean(dim=axis, keepdim=True)
    v = x.var(dim=axis, keepdim=True, unbiased=False)
    return (x - m) / torch.sqrt(v + eps)
def _scatter_add(tgt, idx, src, axis=0):
    return tgt.clone().index_add_(axis, idx, src)
def _segment_sum(src, seg, n):
    out = torch.zeros((n,) + src.shape[1:], dtype=src.dtype)
    return out.index_add_(0, seg, src)
def _pad(x, pw):
    flat = tuple(v for pair in reversed(pw) for v in pair)
    return torch.nn.functional.pad(x, flat)

kernel_name = 'gated_mix__grouped_kv_mqa__geglu_ffn__prompt'

def setup_inputs():

    _w = (lambda a: (lambda t: t.to(torch.bfloat16) if t.is_floating_point() else t)(torch.as_tensor(a)))
    def _A_setup():
        B, S, D, H = 1, 2048, 640, 32
        Dh = D // H
        return {
            "x": _w((lambda *s: torch.randn(*s, dtype=torch.bfloat16) * 0.05)(B, S, D)),
            "wq": _w((lambda *s: torch.randn(*s, dtype=torch.bfloat16) * 0.8)(D, H * Dh)),
            "wk": _w((lambda *s: torch.randn(*s, dtype=torch.bfloat16) * 0.8)(D, Dh)),
            "wv": _w((lambda *s: torch.randn(*s, dtype=torch.bfloat16) * 0.05)(D, Dh)),
            "wo": _w((lambda *s: torch.randn(*s, dtype=torch.bfloat16) * 0.05)(H * Dh, D)),
        }
    _A_in = _A_setup()

    def _B_setup():
        B, S, D, F = 1, 2048, 640, 1728
        return {
            "x": _w((lambda *s: torch.randn(*s, dtype=torch.bfloat16) * 0.05)(B, S, D)),
            "w_gate": _w((lambda *s: torch.randn(*s, dtype=torch.bfloat16) * 0.05)(D, F)),
            "w_up": _w((lambda *s: torch.randn(*s, dtype=torch.bfloat16) * 0.05)(D, F)),
            "w_down": _w((lambda *s: torch.randn(*s, dtype=torch.bfloat16) * 0.05)(F, D)),
        }
    _B_in = _B_setup()

    return {
        "A_x": _A_in["x"],
        "A_wq": _A_in["wq"],
        "A_wk": _A_in["wk"],
        "A_wv": _A_in["wv"],
        "A_wo": _A_in["wo"],
        "B_x": _B_in["x"],
        "B_w_gate": _B_in["w_gate"],
        "B_w_up": _B_in["w_up"],
        "B_w_down": _B_in["w_down"],
        "gate_w": _w((lambda *s: torch.randn(*s, dtype=torch.bfloat16) * 0.05)(640) * 16.0),
    }

def reference(A_x, A_wq, A_wk, A_wv, A_wo, B_x, B_w_gate, B_w_up, B_w_down, gate_w):
    def _A_ref(x, wq, wk, wv, wo):
        B, S, D = x.shape
        H = 32
        Dh = D // H
        q = (lambda x, *d: x.permute(*d))((x @ wq).reshape(B, S, H, Dh), 0, 2, 1, 3)
        k = x @ wk
        v = x @ wv
        scores = torch.einsum("bhqd,bkd->bhqk", q, k) * (Dh ** -0.5)
        p = _softmax(scores, axis=-1)
        o = torch.einsum("bhqk,bkd->bhqd", p, v)
        return (lambda x, *d: x.permute(*d))(o, 0, 2, 1, 3).reshape(B, S, H * Dh) @ wo

    def _B_ref(x, w_gate, w_up, w_down):
        return (_gelu(x @ w_gate) * (x @ w_up)) @ w_down

    x = A_x
    g = _sigmoid((x * gate_w).sum(-1, keepdims=True))
    a = _A_ref(x, A_wq, A_wk, A_wv, A_wo)
    b = _B_ref(x, B_w_gate, B_w_up, B_w_down)
    return g * a + (1 - g) * b
```

```asm
; @launch grid=(256,1,1) block=(640,1,1) lds=163840
.amdgcn_target "amdgcn-amd-amdhsa--gfx950"
.text
.globl gated_mix__grouped_kv_mqa__geglu_ffn__prompt_kernel
.p2align 8
.type gated_mix__grouped_kv_mqa__geglu_ffn__prompt_kernel,@function
gated_mix__grouped_kv_mqa__geglu_ffn__prompt_kernel:
    s_cmp_ge_u32 s2, 256
    s_cbranch_scc1 gated_mix__grouped_kv_mqa__geglu_ffn__prompt_kernel_end
    s_load_dwordx8 s[4:11], s[0:1], 0
    s_load_dwordx4 s[12:15], s[0:1], 48
    s_load_dwordx2 s[18:19], s[0:1], 96
    v_lshrrev_b32 v2, 6, v0
    v_and_b32 v1, 63, v0
    v_readfirstlane_b32 s22, v2
    s_and_b32 s47, s2, 7
    s_lshr_b32 s51, s2, 3
    s_and_b32 s20, s47, 1
    s_lshl_b32 s20, s20, 2
    s_and_b32 s67, s51, 3
    s_add_u32 s20, s20, s67
    s_lshr_b32 s21, s47, 1
    s_lshr_b32 s68, s51, 2
    s_lshl_b32 s52, s68, 2
    s_add_u32 s21, s21, s52
    s_cmp_lt_u32 s22, 8
    s_cbranch_scc1 gated_mix__grouped_kv_mqa__geglu_ffn__prompt_kernel_comp
    s_setprio 3
    s_load_dwordx2 s[72:73], s[0:1], 88
    s_load_dwordx2 s[74:75], s[0:1], 32
    s_and_b32 s63, s22, 1
    v_mov_b32 v16, 0
    v_lshlrev_b32 v17, 7, v1
    v_lshrrev_b32 v10, 3, v1
    v_lshrrev_b32 v11, 4, v1
    v_and_b32 v12, 7, v1
    v_xor_b32 v12, v12, v11
    v_xor_b32 v11, 4, v12
    s_movk_i32 s54, 1280
    v_mul_u32_u24 v10, s54, v10
    v_lshl_add_u32 v15, v11, 4, v10
    v_lshl_add_u32 v10, v12, 4, v10
    s_mul_i32 s53, s20, 327680
    s_mul_i32 s55, s63, 81920
    s_add_u32 s53, s53, s55
    s_add_u32 s55, s53, 4096
    v_add_u32 v2, s55, v10
    s_add_u32 s55, s53, 13312
    v_add_u32 v3, s55, v15
    s_add_u32 s55, s53, 22528
    v_add_u32 v4, s55, v10
    s_add_u32 s55, s53, 31744
    v_add_u32 v5, s55, v15
    s_add_u32 s55, s53, 45056
    v_add_u32 v6, s55, v10
    s_add_u32 s55, s53, 54272
    v_add_u32 v7, s55, v15
    s_add_u32 s55, s53, 63488
    v_add_u32 v8, s55, v10
    s_add_u32 s55, s53, 72704
    v_add_u32 v9, s55, v15
    s_add_u32 s52, s67, s68
    s_and_b32 s52, s52, 3
    s_mov_b32 s60, 1985229328
    s_mov_b32 s61, 152
    s_cmp_eq_u32 s52, 1
    s_cselect_b32 s60, 2268413985, s60
    s_cselect_b32 s61, 150, s61
    s_cmp_eq_u32 s52, 2
    s_cselect_b32 s60, 1749242114, s60
    s_cselect_b32 s61, 151, s61
    s_cmp_eq_u32 s52, 3
    s_cselect_b32 s60, 1985229328, s60
    s_cselect_b32 s61, 152, s61
    s_and_b32 s52, s60, 15
    s_lshl_b32 s41, s52, 7
    s_lshl_b32 s48, s63, 13
    s_mov_b32 m0, s48
    v_lshrrev_b32 v13, 3, v1
    s_movk_i32 s62, 3456
    v_mul_u32_u24 v13, s62, v13
    v_and_b32 v14, 7, v1
    v_bfe_u32 v15, v1, 4, 1
    v_lshlrev_b32 v15, 2, v15
    v_xor_b32 v14, v14, v15
    v_lshl_add_u32 v13, v14, 4, v13
    s_and_b32 s53, s21, 3
    s_mul_i32 s53, s53, 7
    s_add_u32 s53, s53, s68
    s_lshl_b32 s53, s53, 7
    v_add_u32 v10, s53, v13
    v_add_u32 v11, 26624, v10
    v_add_u32 v12, 53248, v10
    v_add_u32 v13, 79872, v10
    v_lshrrev_b32 v14, 2, v1
    v_mul_u32_u24 v14, s54, v14
    v_and_b32 v15, 3, v1
    v_lshl_add_u32 v14, v15, 4, v14
    s_mul_i32 s53, s21, 40
    s_mul_i32 s55, s63, 20480
    s_add_u32 s53, s53, s55
    v_add_u32 v14, s53, v14
    v_cmp_eq_u32 vcc, 3, v15
    v_mov_b32 v15, 0x7f000000
    s_nop 0
    v_cndmask_b32 v14, v14, v15, vcc
    v_lshlrev_b32 v15, 4, v1
    s_mov_b32 s26, 2625536
    s_mov_b32 s27, 0x20000
    s_mov_b32 s30, 2211840
    s_mov_b32 s31, 0x20000
    s_mov_b32 s34, 819200
    s_mov_b32 s35, 0x20000
    s_sub_u32 s53, s21, 27
    s_cmp_lt_u32 s53, 2
    s_cselect_b32 s38, 25600, 0
    s_mov_b32 s39, 0x20000
    s_lshl_b32 s52, s52, 1
    s_mul_i32 s42, s52, 110592
    s_mul_i32 s43, s52, 40960
    s_mul_i32 s40, s52, 1280
    s_lshl_b32 s51, s63, 10
    s_add_u32 s40, s40, s51
    s_lshl_b32 s49, s63, 12
    s_add_u32 s49, s49, 98304
    s_add_u32 s50, s51, 106496
    s_add_u32 s56, s51, 98304
    s_add_u32 s45, s48, 16384
    s_add_u32 s54, s41, 163840
    s_mov_b32 s44, 0
    s_mov_b32 s46, 0
    s_mov_b32 s58, 2
    s_waitcnt lgkmcnt(0)
    s_sub_u32 s24, s4, 4096
    s_subb_u32 s25, s5, 0
    s_and_b32 s25, s25, 0xffff
    buffer_load_dwordx4 v2, s[24:27], s41 offen lds
    buffer_load_dwordx4 v3, s[24:27], s41 offen offset:1024 lds
    buffer_load_dwordx4 v4, s[24:27], s41 offen offset:2048 lds
    buffer_load_dwordx4 v5, s[24:27], s41 offen offset:3072 lds
    s_add_u32 m0, m0, 4096
    s_nop 0
    buffer_load_dwordx4 v6, s[24:27], s41 offen lds
    buffer_load_dwordx4 v7, s[24:27], s41 offen offset:1024 lds
    buffer_load_dwordx4 v8, s[24:27], s41 offen offset:2048 lds
    buffer_load_dwordx4 v9, s[24:27], s41 offen offset:3072 lds
    s_cmp_eq_u32 s63, 1
    s_cselect_b32 s28, s14, s12
    s_cselect_b32 s29, s15, s13
    s_and_b32 s29, s29, 0xffff
    s_mov_b32 s32, s6
    s_and_b32 s33, s7, 0xffff
    s_cmp_eq_u32 s21, 27
    s_cselect_b32 s36, s8, s10
    s_cselect_b32 s37, s9, s11
    s_and_b32 s37, s37, 0xffff
    s_mov_b32 s8, s18
    s_and_b32 s9, s19, 0xffff
    s_mov_b32 s10, 33554432
    s_mov_b32 s11, 0x20000
    s_mov_b32 s12, s18
    s_and_b32 s13, s19, 0xffff
    s_mov_b32 s14, 3342336
    s_mov_b32 s15, 0x20000
    s_mov_b32 s69, 3440640
    s_cmp_ge_u32 s21, 27
    s_cbranch_scc1 gated_mix__grouped_kv_mqa__geglu_ffn__prompt_kernel_ldl_issue
gated_mix__grouped_kv_mqa__geglu_ffn__prompt_kernel_ldf_issue:
    s_mov_b32 m0, s45
    s_add_u32 s46, s46, 1
    buffer_load_dwordx4 v2, s[24:27], s54 offen lds
    buffer_load_dwordx4 v3, s[24:27], s54 offen offset:1024 lds
    buffer_load_dwordx4 v4, s[24:27], s54 offen offset:2048 lds
    buffer_load_dwordx4 v5, s[24:27], s54 offen offset:3072 lds
    s_add_u32 m0, m0, 4096
    s_nop 0
    buffer_load_dwordx4 v6, s[24:27], s54 offen lds
    buffer_load_dwordx4 v7, s[24:27], s54 offen offset:1024 lds
    buffer_load_dwordx4 v8, s[24:27], s54 offen offset:2048 lds
    buffer_load_dwordx4 v9, s[24:27], s54 offen offset:3072 lds
    s_add_u32 m0, s44, s49
    s_add_u32 s45, s45, 16384
    buffer_load_dwordx4 v10, s[28:31], s42 offen lds
    buffer_load_dwordx4 v11, s[28:31], s42 offen offset:1024 lds
    buffer_load_dwordx4 v12, s[28:31], s42 offen offset:2048 lds
    buffer_load_dwordx4 v13, s[28:31], s42 offen offset:3072 lds
    s_add_u32 m0, s44, s50
    s_lshr_b32 s52, s46, 1
    buffer_load_dwordx4 v14, s[32:35], s43 offen lds
    s_lshl_b32 s52, s52, 2
    s_lshr_b64 s[64:65], s[60:61], s52
    s_and_b32 s52, s64, 15
    s_lshl_b32 s52, s52, 1
    s_and_b32 s53, s46, 1
    s_add_u32 s52, s52, s53
    s_mul_i32 s42, s52, 110592
    s_mul_i32 s43, s52, 40960
    s_mul_i32 s40, s52, 1280
    s_add_u32 s40, s40, s51
    s_lshl_b32 s52, s53, 2
    s_lshr_b32 s52, s64, s52
    s_and_b32 s52, s52, 15
    s_lshl_b32 s54, s52, 7
    s_cmp_eq_u32 s53, 0
    s_cselect_b32 s52, 163840, 0
    s_add_u32 s54, s54, s52
    s_add_u32 s44, s44, 10240
    s_cmp_ge_u32 s44, 40960
    s_cselect_b32 s44, 0, s44
    s_cmp_ge_u32 s45, 98304
    s_cselect_b32 s45, s48, s45
    s_cmp_eq_u32 s46, 19
    s_cselect_b32 s26, 0, s26
    s_cmp_lg_u32 s46, 12
    s_cbranch_scc1 gated_mix__grouped_kv_mqa__geglu_ffn__prompt_kernel_ld_e1
    global_load_dwordx2 v[20:21], v16, s[72:73] sc0 sc1
gated_mix__grouped_kv_mqa__geglu_ffn__prompt_kernel_ld_e1:
    s_cmp_lg_u32 s46, 19
    s_cbranch_scc1 gated_mix__grouped_kv_mqa__geglu_ffn__prompt_kernel_ld_e2
    s_mov_b64 exec, 0xffff
    buffer_load_dwordx2 v[24:25], v17, s[8:11], s69 offen sc1
    s_mov_b64 exec, -1
gated_mix__grouped_kv_mqa__geglu_ffn__prompt_kernel_ld_e2:
    s_cmp_lt_u32 s46, s58
    s_cbranch_scc1 gated_mix__grouped_kv_mqa__geglu_ffn__prompt_kernel_ldf_issue
    s_waitcnt vmcnt(13)
    s_barrier
    s_add_u32 s58, s58, 1
    s_cmp_le_u32 s58, 20
    s_cbranch_scc1 gated_mix__grouped_kv_mqa__geglu_ffn__prompt_kernel_ldf_issue
    s_branch gated_mix__grouped_kv_mqa__geglu_ffn__prompt_kernel_ld_tailf
gated_mix__grouped_kv_mqa__geglu_ffn__prompt_kernel_ldl_issue:
    s_mov_b32 m0, s45
    s_add_u32 s46, s46, 1
    buffer_load_dwordx4 v2, s[24:27], s54 offen lds
    buffer_load_dwordx4 v3, s[24:27], s54 offen offset:1024 lds
    buffer_load_dwordx4 v4, s[24:27], s54 offen offset:2048 lds
    buffer_load_dwordx4 v5, s[24:27], s54 offen offset:3072 lds
    s_add_u32 m0, m0, 4096
    s_nop 0
    buffer_load_dwordx4 v6, s[24:27], s54 offen lds
    buffer_load_dwordx4 v7, s[24:27], s54 offen offset:1024 lds
    buffer_load_dwordx4 v8, s[24:27], s54 offen offset:2048 lds
    buffer_load_dwordx4 v9, s[24:27], s54 offen offset:3072 lds
    s_add_u32 m0, s44, s56
    s_add_u32 s45, s45, 16384
    buffer_load_dwordx4 v15, s[36:39], s40 offen lds
    s_add_u32 m0, s44, s50
    s_lshr_b32 s52, s46, 1
    buffer_load_dwordx4 v14, s[32:35], s43 offen lds
    s_lshl_b32 s52, s52, 2
    s_lshr_b64 s[64:65], s[60:61], s52
    s_and_b32 s52, s64, 15
    s_lshl_b32 s52, s52, 1
    s_and_b32 s53, s46, 1
    s_add_u32 s52, s52, s53
    s_mul_i32 s42, s52, 110592
    s_mul_i32 s43, s52, 40960
    s_mul_i32 s40, s52, 1280
    s_add_u32 s40, s40, s51
    s_lshl_b32 s52, s53, 2
    s_lshr_b32 s52, s64, s52
    s_and_b32 s52, s52, 15
    s_lshl_b32 s54, s52, 7
    s_cmp_eq_u32 s53, 0
    s_cselect_b32 s52, 163840, 0
    s_add_u32 s54, s54, s52
    s_add_u32 s44, s44, 10240
    s_cmp_ge_u32 s44, 40960
    s_cselect_b32 s44, 0, s44
    s_cmp_ge_u32 s45, 98304
    s_cselect_b32 s45, s48, s45
    s_cmp_eq_u32 s46, 19
    s_cselect_b32 s26, 0, s26
    s_cmp_lt_u32 s46, s58
    s_cbranch_scc1 gated_mix__grouped_kv_mqa__geglu_ffn__prompt_kernel_ldl_issue
    s_waitcnt vmcnt(10)
    s_barrier
    s_add_u32 s58, s58, 1
    s_cmp_le_u32 s58, 20
    s_cbranch_scc1 gated_mix__grouped_kv_mqa__geglu_ffn__prompt_kernel_ldl_issue
    s_branch gated_mix__grouped_kv_mqa__geglu_ffn__prompt_kernel_ld_tail
gated_mix__grouped_kv_mqa__geglu_ffn__prompt_kernel_ld_tailf:
    s_mov_b64 exec, 0xffff
    v_cmp_ne_u64 vcc, v[24:25], v[20:21]
    v_cmp_eq_u32 s[52:53], 0, v20
    s_mov_b64 exec, -1
    s_or_b64 s[52:53], s[52:53], vcc
    s_cmp_lg_u64 s[52:53], 0
    s_cbranch_scc1 gated_mix__grouped_kv_mqa__geglu_ffn__prompt_kernel_ld_tail
    v_mov_b32 v5, 0
    v_lshlrev_b32 v2, 4, v1
    v_lshlrev_b32 v3, 7, v1
    s_lshl_b32 s33, s20, 5
    s_add_u32 s33, s33, s21
    s_lshl_b32 s34, s33, 7
    s_add_u32 s34, s34, 3407872
    s_lshl_b32 s35, s20, 12
    s_add_u32 s35, s35, 3407872
    s_mul_i32 s24, s63, 6144
    s_add_u32 s30, s24, 3145728
    s_add_u32 s31, s30, 4096
    s_add_u32 s24, s24, 126976
    s_mov_b32 s25, 12288
    s_mov_b32 m0, 32768
    s_mov_b32 s52, 3147260
    v_mul_u32_u24 v6, 3072, v1
    buffer_load_dword v6, s[8:11], s52 offen sc1 lds
    s_add_u32 m0, s25, s24
    s_add_u32 s25, s25, 12288
    buffer_load_dwordx4 v2, s[12:15], s30 offen sc1 lds
    buffer_load_dwordx4 v2, s[12:15], s30 offen offset:1024 sc1 lds
    buffer_load_dwordx4 v2, s[12:15], s30 offen offset:2048 sc1 lds
    buffer_load_dwordx4 v2, s[12:15], s30 offen offset:3072 sc1 lds
    s_add_u32 m0, m0, 4096
    s_add_u32 s30, s30, 12288
    buffer_load_dwordx4 v2, s[12:15], s31 offen sc1 lds
    buffer_load_dwordx4 v2, s[12:15], s31 offen offset:1024 sc1 lds
    s_add_u32 s31, s31, 12288
    s_cmp_ge_u32 s25, 36864
    s_cselect_b32 s25, 0, s25
    s_add_u32 m0, s25, s24
    s_add_u32 s25, s25, 12288
    buffer_load_dwordx4 v2, s[12:15], s30 offen sc1 lds
    buffer_load_dwordx4 v2, s[12:15], s30 offen offset:1024 sc1 lds
    buffer_load_dwordx4 v2, s[12:15], s30 offen offset:2048 sc1 lds
    buffer_load_dwordx4 v2, s[12:15], s30 offen offset:3072 sc1 lds
    s_add_u32 m0, m0, 4096
    s_add_u32 s30, s30, 12288
    buffer_load_dwordx4 v2, s[12:15], s31 offen sc1 lds
    buffer_load_dwordx4 v2, s[12:15], s31 offen offset:1024 sc1 lds
    s_add_u32 s31, s31, 12288
    s_cmp_ge_u32 s25, 36864
    s_cselect_b32 s25, 0, s25
    s_waitcnt vmcnt(13)
    s_barrier
    s_barrier
    s_branch gated_mix__grouped_kv_mqa__geglu_ffn__prompt_kernel_l_kvok
gated_mix__grouped_kv_mqa__geglu_ffn__prompt_kernel_ld_tail:
    s_waitcnt vmcnt(0)
    s_barrier
    global_load_dwordx2 v[20:21], v16, s[72:73] sc0 sc1
    s_barrier
    v_mov_b32 v5, 0
    v_lshlrev_b32 v2, 4, v1
    v_lshlrev_b32 v3, 7, v1
    s_lshl_b32 s33, s20, 5
    s_add_u32 s33, s33, s21
    s_lshl_b32 s34, s33, 7
    s_add_u32 s34, s34, 3407872
    s_lshl_b32 s35, s20, 12
    s_add_u32 s35, s35, 3407872
    s_mul_i32 s24, s63, 6144
    s_add_u32 s30, s24, 3145728
    s_add_u32 s31, s30, 4096
    s_add_u32 s24, s24, 126976
    s_mov_b32 s25, 12288
    s_mov_b32 s70, 65536
    s_branch gated_mix__grouped_kv_mqa__geglu_ffn__prompt_kernel_l_non2
gated_mix__grouped_kv_mqa__geglu_ffn__prompt_kernel_l_non:
    global_load_dwordx2 v[20:21], v16, s[72:73] sc0 sc1
gated_mix__grouped_kv_mqa__geglu_ffn__prompt_kernel_l_non2:
    s_sub_u32 s70, s70, 1
    s_cbranch_scc1 gated_mix__grouped_kv_mqa__geglu_ffn__prompt_kernel_l_non3
    s_waitcnt vmcnt(0)
    v_cmp_ne_u32 vcc, 0, v20
    s_cmp_eq_u64 vcc, 0
    s_cbranch_scc1 gated_mix__grouped_kv_mqa__geglu_ffn__prompt_kernel_l_non
gated_mix__grouped_kv_mqa__geglu_ffn__prompt_kernel_l_non3:
    s_sub_u32 s53, s21, 27
    s_cmp_ge_u32 s53, 2
    s_cbranch_scc1 gated_mix__grouped_kv_mqa__geglu_ffn__prompt_kernel_l_nokv
    s_barrier
    s_cmp_lg_u32 s63, 0
    s_cbranch_scc1 gated_mix__grouped_kv_mqa__geglu_ffn__prompt_kernel_l_nokv
    s_lshl_b32 s52, s20, 1
    s_add_u32 s52, s52, s53
    s_lshl_b32 s52, s52, 7
    s_add_u32 s52, s52, 3440640
    s_mov_b64 exec, 1
    buffer_store_dwordx2 v[20:21], v5, s[8:11], s52 offen sc1
    s_mov_b64 exec, -1
gated_mix__grouped_kv_mqa__geglu_ffn__prompt_kernel_l_nokv:
    s_cmp_lt_u32 s21, 27
    s_cbranch_scc1 gated_mix__grouped_kv_mqa__geglu_ffn__prompt_kernel_l_now
    s_cmp_eq_u32 s63, 0
    s_cbranch_scc1 gated_mix__grouped_kv_mqa__geglu_ffn__prompt_kernel_l_now
    s_load_dwordx2 s[16:17], s[0:1], 64
    s_mul_i32 s52, s20, 5
    s_add_u32 s52, s52, s53
    s_mul_i32 s52, s52, 57344
    s_waitcnt lgkmcnt(0)
    s_mov_b32 s56, s16
    s_and_b32 s57, s17, 0xffff
    s_mov_b32 s58, 2211840
    s_mov_b32 s59, 0x20000
    s_mov_b32 s54, 7
gated_mix__grouped_kv_mqa__geglu_ffn__prompt_kernel_l_warm:
    buffer_load_dword v31, v3, s[56:59], s52 offen
    s_add_u32 s52, s52, 8192
    s_sub_u32 s54, s54, 1
    s_cmp_lg_u32 s54, 0
    s_cbranch_scc1 gated_mix__grouped_kv_mqa__geglu_ffn__prompt_kernel_l_warm
gated_mix__grouped_kv_mqa__geglu_ffn__prompt_kernel_l_now:
    s_mov_b64 exec, 0xffff
    s_mov_b32 s70, 65536
gated_mix__grouped_kv_mqa__geglu_ffn__prompt_kernel_poll1:
    buffer_load_dwordx2 v[24:25], v3, s[8:11], s69 offen sc1
    s_sub_u32 s70, s70, 1
    s_cbranch_scc1 gated_mix__grouped_kv_mqa__geglu_ffn__prompt_kernel_poll1_ok
    s_waitcnt vmcnt(0)
    v_cmp_ne_u64 vcc, v[24:25], v[20:21]
    s_cmp_eq_u64 vcc, 0
    s_cbranch_scc1 gated_mix__grouped_kv_mqa__geglu_ffn__prompt_kernel_poll1_ok
    s_sleep 2
    s_branch gated_mix__grouped_kv_mqa__geglu_ffn__prompt_kernel_poll1
gated_mix__grouped_kv_mqa__geglu_ffn__prompt_kernel_poll1_ok:
    s_mov_b64 exec, -1
    s_mov_b32 m0, 32768
    s_mov_b32 s52, 3147260
    v_mul_u32_u24 v6, 3072, v1
    buffer_load_dword v6, s[8:11], s52 offen sc1 lds
    s_add_u32 m0, s25, s24
    s_add_u32 s25, s25, 12288
    buffer_load_dwordx4 v2, s[12:15], s30 offen sc1 lds
    buffer_load_dwordx4 v2, s[12:15], s30 offen offset:1024 sc1 lds
    buffer_load_dwordx4 v2, s[12:15], s30 offen offset:2048 sc1 lds
    buffer_load_dwordx4 v2, s[12:15], s30 offen offset:3072 sc1 lds
    s_add_u32 m0, m0, 4096
    s_add_u32 s30, s30, 12288
    buffer_load_dwordx4 v2, s[12:15], s31 offen sc1 lds
    buffer_load_dwordx4 v2, s[12:15], s31 offen offset:1024 sc1 lds
    s_add_u32 s31, s31, 12288
    s_cmp_ge_u32 s25, 36864
    s_cselect_b32 s25, 0, s25
    s_add_u32 m0, s25, s24
    s_add_u32 s25, s25, 12288
    buffer_load_dwordx4 v2, s[12:15], s30 offen sc1 lds
    buffer_load_dwordx4 v2, s[12:15], s30 offen offset:1024 sc1 lds
    buffer_load_dwordx4 v2, s[12:15], s30 offen offset:2048 sc1 lds
    buffer_load_dwordx4 v2, s[12:15], s30 offen offset:3072 sc1 lds
    s_add_u32 m0, m0, 4096
    s_add_u32 s30, s30, 12288
    buffer_load_dwordx4 v2, s[12:15], s31 offen sc1 lds
    buffer_load_dwordx4 v2, s[12:15], s31 offen offset:1024 sc1 lds
    s_add_u32 s31, s31, 12288
    s_cmp_ge_u32 s25, 36864
    s_cselect_b32 s25, 0, s25
gated_mix__grouped_kv_mqa__geglu_ffn__prompt_kernel_l_kvok:
    s_setprio 0
    s_lshr_b32 s38, s21, 2
    s_mul_i32 s38, s38, 160
    s_movk_i32 s39, 5462
    s_movk_i32 s40, 1280
    v_add_u32 v6, 0, v1
    v_mul_u32_u24 v7, s39, v6
    v_lshrrev_b32 v7, 16, v7
    v_mul_u32_u24 v8, 12, v7
    v_sub_u32 v8, v6, v8
    v_mul_u32_u24 v7, s40, v7
    v_lshl_add_u32 v7, v8, 4, v7
    v_add_u32 v7, s38, v7
    v_subrev_u32 v10, 0, v7
    v_add_u32 v6, 64, v1
    v_mul_u32_u24 v7, s39, v6
    v_lshrrev_b32 v7, 16, v7
    v_mul_u32_u24 v8, 12, v7
    v_sub_u32 v8, v6, v8
    v_mul_u32_u24 v7, s40, v7
    v_lshl_add_u32 v7, v8, 4, v7
    v_add_u32 v7, s38, v7
    v_subrev_u32 v11, 1024, v7
    v_add_u32 v6, 128, v1
    v_mul_u32_u24 v7, s39, v6
    v_lshrrev_b32 v7, 16, v7
    v_mul_u32_u24 v8, 12, v7
    v_sub_u32 v8, v6, v8
    v_mul_u32_u24 v7, s40, v7
    v_lshl_add_u32 v7, v8, 4, v7
    v_add_u32 v7, s38, v7
    v_subrev_u32 v12, 2048, v7
    s_mov_b32 s40, s74
    s_and_b32 s41, s75, 0xffff
    s_mov_b32 s42, 819200
    s_mov_b32 s43, 0x20000
    s_mul_i32 s44, s63, 409600
    s_mul_i32 s45, s63, 61440
    s_waitcnt vmcnt(6)
    s_barrier
    s_waitcnt vmcnt(0)
    s_barrier
    s_add_u32 m0, s25, s24
    s_add_u32 s25, s25, 12288
    buffer_load_dwordx4 v2, s[12:15], s30 offen sc1 lds
    buffer_load_dwordx4 v2, s[12:15], s30 offen offset:1024 sc1 lds
    buffer_load_dwordx4 v2, s[12:15], s30 offen offset:2048 sc1 lds
    buffer_load_dwordx4 v2, s[12:15], s30 offen offset:3072 sc1 lds
    s_add_u32 m0, m0, 4096
    s_add_u32 s30, s30, 12288
    buffer_load_dwordx4 v2, s[12:15], s31 offen sc1 lds
    buffer_load_dwordx4 v2, s[12:15], s31 offen offset:1024 sc1 lds
    s_add_u32 s31, s31, 12288
    s_cmp_ge_u32 s25, 36864
    s_cselect_b32 s25, 0, s25
    s_cmp_eq_u32 s63, 1
    s_cbranch_scc1 gated_mix__grouped_kv_mqa__geglu_ffn__prompt_kernel_gate
    s_lshl_b32 s52, s2, 6
    v_add_u32 v6, s52, v1
    v_lshlrev_b32 v6, 7, v6
    buffer_load_dword v30, v6, s[40:43], 0 offen
    v_mov_b32 v6, 122880
    ds_write_b64 v6, v[20:21]
    v_mov_b32 v8, 0
    v_mov_b32 v9, 0
    ds_write_b64 v6, v[8:9] offset:8
    ds_write_b64 v6, v[8:9] offset:16
    ds_write_b64 v6, v[8:9] offset:24
    s_waitcnt vmcnt(1) lgkmcnt(0)
    s_barrier
    s_mov_b64 exec, 1
    buffer_store_dwordx2 v[20:21], v5, s[8:11], s34 offen sc1
    s_mov_b64 exec, -1
    s_add_u32 m0, s25, s24
    s_add_u32 s25, s25, 12288
    buffer_load_dwordx4 v2, s[12:15], s30 offen sc1 lds
    buffer_load_dwordx4 v2, s[12:15], s30 offen offset:1024 sc1 lds
    buffer_load_dwordx4 v2, s[12:15], s30 offen offset:2048 sc1 lds
    buffer_load_dwordx4 v2, s[12:15], s30 offen offset:3072 sc1 lds
    s_add_u32 m0, m0, 4096
    s_add_u32 s30, s30, 12288
    buffer_load_dwordx4 v2, s[12:15], s31 offen sc1 lds
    buffer_load_dwordx4 v2, s[12:15], s31 offen offset:1024 sc1 lds
    s_add_u32 s31, s31, 12288
    s_cmp_ge_u32 s25, 36864
    s_cselect_b32 s25, 0, s25
    s_waitcnt vmcnt(0)
    s_branch gated_mix__grouped_kv_mqa__geglu_ffn__prompt_kernel_gate_done
gated_mix__grouped_kv_mqa__geglu_ffn__prompt_kernel_gate:
    s_load_dwordx2 s[16:17], s[0:1], 72
    s_load_dwordx2 s[4:5], s[0:1], 0
    v_and_b32 v16, 7, v1
    v_lshlrev_b32 v16, 4, v16
    v_lshrrev_b32 v17, 3, v1
    s_lshl_b32 s53, s33, 3
    v_add_u32 v18, s53, v17
    s_movk_i32 s54, 1280
    v_mul_lo_u32 v17, v18, s54
    v_add_u32 v17, v17, v16
    s_waitcnt lgkmcnt(0)
    s_mov_b32 s56, s4
    s_and_b32 s57, s5, 0xffff
    s_mov_b32 s58, 2621440
    s_mov_b32 s59, 0x20000
    s_mov_b32 s68, s16
    s_and_b32 s69, s17, 0xffff
    s_mov_b32 s70, 1280
    s_mov_b32 s71, 0x20000
    buffer_load_dwordx4 v[72:75], v17, s[56:59], 0 offen offset:0
    buffer_load_dwordx4 v[76:79], v17, s[56:59], 0 offen offset:128
    buffer_load_dwordx4 v[80:83], v17, s[56:59], 0 offen offset:256
    buffer_load_dwordx4 v[84:87], v17, s[56:59], 0 offen offset:384
    buffer_load_dwordx4 v[88:91], v17, s[56:59], 0 offen offset:512
    buffer_load_dwordx4 v[92:95], v17, s[56:59], 0 offen offset:640
    buffer_load_dwordx4 v[96:99], v17, s[56:59], 0 offen offset:768
    buffer_load_dwordx4 v[100:103], v17, s[56:59], 0 offen offset:896
    buffer_load_dwordx4 v[104:107], v17, s[56:59], 0 offen offset:1024
    buffer_load_dwordx4 v[108:111], v17, s[56:59], 0 offen offset:1152
    buffer_load_dwordx4 v[32:35], v16, s[68:71], 0 offen offset:0
    buffer_load_dwordx4 v[36:39], v16, s[68:71], 0 offen offset:128
    buffer_load_dwordx4 v[40:43], v16, s[68:71], 0 offen offset:256
    buffer_load_dwordx4 v[44:47], v16, s[68:71], 0 offen offset:384
    buffer_load_dwordx4 v[48:51], v16, s[68:71], 0 offen offset:512
    buffer_load_dwordx4 v[52:55], v16, s[68:71], 0 offen offset:640
    buffer_load_dwordx4 v[56:59], v16, s[68:71], 0 offen offset:768
    buffer_load_dwordx4 v[60:63], v16, s[68:71], 0 offen offset:896
    buffer_load_dwordx4 v[64:67], v16, s[68:71], 0 offen offset:1024
    buffer_load_dwordx4 v[68:71], v16, s[68:71], 0 offen offset:1152
    v_lshrrev_b32 v19, 3, v1
    v_lshlrev_b32 v19, 2, v19
    v_mov_b32 v27, 0xbfb8aa3b
    v_mov_b32 v26, 0
    v_mov_b32 v28, 0
    s_waitcnt vmcnt(20)
    s_barrier
    s_add_u32 m0, s25, s24
    s_add_u32 s25, s25, 12288
    buffer_load_dwordx4 v2, s[12:15], s30 offen sc1 lds
    buffer_load_dwordx4 v2, s[12:15], s30 offen offset:1024 sc1 lds
    buffer_load_dwordx4 v2, s[12:15], s30 offen offset:2048 sc1 lds
    buffer_load_dwordx4 v2, s[12:15], s30 offen offset:3072 sc1 lds
    s_add_u32 m0, m0, 4096
    s_add_u32 s30, s30, 12288
    buffer_load_dwordx4 v2, s[12:15], s31 offen sc1 lds
    buffer_load_dwordx4 v2, s[12:15], s31 offen offset:1024 sc1 lds
    s_add_u32 s31, s31, 12288
    s_cmp_ge_u32 s25, 36864
    s_cselect_b32 s25, 0, s25
    s_waitcnt vmcnt(6)
    v_dot2_f32_bf16 v26, v72, v32, v26
    v_dot2_f32_bf16 v28, v73, v33, v28
    v_dot2_f32_bf16 v26, v74, v34, v26
    v_dot2_f32_bf16 v28, v75, v35, v28
    v_dot2_f32_bf16 v26, v76, v36, v26
    v_dot2_f32_bf16 v28, v77, v37, v28
    v_dot2_f32_bf16 v26, v78, v38, v26
    v_dot2_f32_bf16 v28, v79, v39, v28
    v_dot2_f32_bf16 v26, v80, v40, v26
    v_dot2_f32_bf16 v28, v81, v41, v28
    v_dot2_f32_bf16 v26, v82, v42, v26
    v_dot2_f32_bf16 v28, v83, v43, v28
    v_dot2_f32_bf16 v26, v84, v44, v26
    v_dot2_f32_bf16 v28, v85, v45, v28
    v_dot2_f32_bf16 v26, v86, v46, v26
    v_dot2_f32_bf16 v28, v87, v47, v28
    v_dot2_f32_bf16 v26, v88, v48, v26
    v_dot2_f32_bf16 v28, v89, v49, v28
    v_dot2_f32_bf16 v26, v90, v50, v26
    v_dot2_f32_bf16 v28, v91, v51, v28
    v_dot2_f32_bf16 v26, v92, v52, v26
    v_dot2_f32_bf16 v28, v93, v53, v28
    v_dot2_f32_bf16 v26, v94, v54, v26
    v_dot2_f32_bf16 v28, v95, v55, v28
    v_dot2_f32_bf16 v26, v96, v56, v26
    v_dot2_f32_bf16 v28, v97, v57, v28
    v_dot2_f32_bf16 v26, v98, v58, v26
    v_dot2_f32_bf16 v28, v99, v59, v28
    v_dot2_f32_bf16 v26, v100, v60, v26
    v_dot2_f32_bf16 v28, v101, v61, v28
    v_dot2_f32_bf16 v26, v102, v62, v26
    v_dot2_f32_bf16 v28, v103, v63, v28
    v_dot2_f32_bf16 v26, v104, v64, v26
    v_dot2_f32_bf16 v28, v105, v65, v28
    v_dot2_f32_bf16 v26, v106, v66, v26
    v_dot2_f32_bf16 v28, v107, v67, v28
    v_dot2_f32_bf16 v26, v108, v68, v26
    v_dot2_f32_bf16 v28, v109, v69, v28
    v_dot2_f32_bf16 v26, v110, v70, v26
    v_dot2_f32_bf16 v28, v111, v71, v28
    s_nop 3
    v_add_f32 v26, v26, v28
    s_nop 1
    v_add_f32_dpp v26, v26, v26 quad_perm:[1,0,3,2] row_mask:0xf bank_mask:0xf
    s_nop 1
    v_add_f32_dpp v26, v26, v26 quad_perm:[2,3,0,1] row_mask:0xf bank_mask:0xf
    s_nop 1
    v_add_f32_dpp v26, v26, v26 row_half_mirror row_mask:0xf bank_mask:0xf
    v_cvt_pk_bf16_f32 v26, v26, v26
    v_lshlrev_b32 v26, 16, v26
    v_mul_f32 v26, v27, v26
    v_exp_f32 v26, v26
    s_nop 0
    v_add_f32 v26, 1.0, v26
    v_rcp_f32 v26, v26
    s_nop 0
    v_cvt_pk_bf16_f32 v26, v26, v26
    v_lshlrev_b32 v28, 16, v26
    s_lshl_b32 s53, s33, 7
    s_add_u32 s53, s53, 3670016
    v_cmp_eq_u32 vcc, 0, v16
    s_nop 1
    s_mov_b64 exec, vcc
    buffer_store_dword v28, v19, s[8:11], s53 offen sc1
    s_mov_b64 exec, -1
    s_waitcnt vmcnt(1)
gated_mix__grouped_kv_mqa__geglu_ffn__prompt_kernel_gate_done:
    s_barrier
    s_add_u32 m0, s25, s24
    s_add_u32 s25, s25, 12288
    buffer_load_dwordx4 v2, s[12:15], s30 offen sc1 lds
    buffer_load_dwordx4 v2, s[12:15], s30 offen offset:1024 sc1 lds
    buffer_load_dwordx4 v2, s[12:15], s30 offen offset:2048 sc1 lds
    buffer_load_dwordx4 v2, s[12:15], s30 offen offset:3072 sc1 lds
    s_add_u32 m0, m0, 4096
    s_add_u32 s30, s30, 12288
    buffer_load_dwordx4 v2, s[12:15], s31 offen sc1 lds
    buffer_load_dwordx4 v2, s[12:15], s31 offen offset:1024 sc1 lds
    s_add_u32 s31, s31, 12288
    s_cmp_ge_u32 s25, 36864
    s_cselect_b32 s25, 0, s25
    s_cmp_eq_u32 s63, 1
    s_cbranch_scc1 gated_mix__grouped_kv_mqa__geglu_ffn__prompt_kernel_l_np
    s_mov_b64 exec, 0x7ffffff
    s_mov_b32 s70, 65536
gated_mix__grouped_kv_mqa__geglu_ffn__prompt_kernel_poll2:
    buffer_load_dwordx2 v[24:25], v3, s[8:11], s35 offen sc1
    s_sub_u32 s70, s70, 1
    s_cbranch_scc1 gated_mix__grouped_kv_mqa__geglu_ffn__prompt_kernel_poll2_ok
    s_waitcnt vmcnt(0)
    v_cmp_ne_u64 vcc, v[24:25], v[20:21]
    s_cmp_eq_u64 vcc, 0
    s_cbranch_scc1 gated_mix__grouped_kv_mqa__geglu_ffn__prompt_kernel_poll2_ok
    s_sleep 2
    s_branch gated_mix__grouped_kv_mqa__geglu_ffn__prompt_kernel_poll2
gated_mix__grouped_kv_mqa__geglu_ffn__prompt_kernel_poll2_ok:
    s_mov_b64 exec, -1
gated_mix__grouped_kv_mqa__geglu_ffn__prompt_kernel_l_np:
    s_mov_b32 s46, 3
gated_mix__grouped_kv_mqa__geglu_ffn__prompt_kernel_lloop:
    s_waitcnt vmcnt(0)
    s_barrier
    s_add_u32 m0, s25, s24
    s_add_u32 s25, s25, 12288
    buffer_load_dwordx4 v2, s[12:15], s30 offen sc1 lds
    buffer_load_dwordx4 v2, s[12:15], s30 offen offset:1024 sc1 lds
    buffer_load_dwordx4 v2, s[12:15], s30 offen offset:2048 sc1 lds
    buffer_load_dwordx4 v2, s[12:15], s30 offen offset:3072 sc1 lds
    s_add_u32 m0, m0, 4096
    s_add_u32 s30, s30, 12288
    buffer_load_dwordx4 v2, s[12:15], s31 offen sc1 lds
    buffer_load_dwordx4 v2, s[12:15], s31 offen offset:1024 sc1 lds
    s_add_u32 s31, s31, 12288
    s_cmp_ge_u32 s25, 36864
    s_cselect_b32 s25, 0, s25
    s_add_u32 s46, s46, 1
    s_cmp_lt_u32 s46, 14
    s_cbranch_scc1 gated_mix__grouped_kv_mqa__geglu_ffn__prompt_kernel_lloop
    s_setprio 0
    s_add_u32 s34, s34, 65536
    s_add_u32 s35, s35, 65536
    s_mov_b32 s47, 8
gated_mix__grouped_kv_mqa__geglu_ffn__prompt_kernel_woa:
    s_mov_b32 m0, s45
    s_add_u32 s45, s45, 3072
    buffer_load_dwordx4 v10, s[40:43], s44 offen lds
    buffer_load_dwordx4 v11, s[40:43], s44 offen offset:1024 lds
    buffer_load_dwordx4 v12, s[40:43], s44 offen offset:2048 lds
    s_add_u32 s44, s44, 20480
    s_sub_u32 s47, s47, 1
    s_cmp_lg_u32 s47, 0
    s_cbranch_scc1 gated_mix__grouped_kv_mqa__geglu_ffn__prompt_kernel_woa
    s_waitcnt vmcnt(24)
    s_barrier
    s_cmp_lg_u32 s63, 0
    s_cbranch_scc1 gated_mix__grouped_kv_mqa__geglu_ffn__prompt_kernel_l_nf2
    s_mov_b64 exec, 1
    buffer_store_dwordx2 v[20:21], v5, s[8:11], s34 offen sc1
    s_mov_b64 exec, -1
gated_mix__grouped_kv_mqa__geglu_ffn__prompt_kernel_l_nf2:
    s_mov_b32 s47, 8
gated_mix__grouped_kv_mqa__geglu_ffn__prompt_kernel_wob:
    s_mov_b32 m0, s45
    s_add_u32 s45, s45, 3072
    buffer_load_dwordx4 v10, s[40:43], s44 offen lds
    buffer_load_dwordx4 v11, s[40:43], s44 offen offset:1024 lds
    buffer_load_dwordx4 v12, s[40:43], s44 offen offset:2048 lds
    s_add_u32 s44, s44, 20480
    s_sub_u32 s47, s47, 1
    s_cmp_lg_u32 s47, 0
    s_cbranch_scc1 gated_mix__grouped_kv_mqa__geglu_ffn__prompt_kernel_wob
    s_barrier
    s_mov_b32 s47, 4
gated_mix__grouped_kv_mqa__geglu_ffn__prompt_kernel_woc:
    s_mov_b32 m0, s45
    s_add_u32 s45, s45, 3072
    buffer_load_dwordx4 v10, s[40:43], s44 offen lds
    buffer_load_dwordx4 v11, s[40:43], s44 offen offset:1024 lds
    buffer_load_dwordx4 v12, s[40:43], s44 offen offset:2048 lds
    s_add_u32 s44, s44, 20480
    s_sub_u32 s47, s47, 1
    s_cmp_lg_u32 s47, 0
    s_cbranch_scc1 gated_mix__grouped_kv_mqa__geglu_ffn__prompt_kernel_woc
    s_cmp_eq_u32 s63, 0
    s_cbranch_scc1 gated_mix__grouped_kv_mqa__geglu_ffn__prompt_kernel_l_np2
    s_mov_b32 exec_hi, 0
    s_mov_b32 s70, 65536
gated_mix__grouped_kv_mqa__geglu_ffn__prompt_kernel_poll3:
    buffer_load_dwordx2 v[24:25], v3, s[8:11], s35 offen sc1
    s_sub_u32 s70, s70, 1
    s_cbranch_scc1 gated_mix__grouped_kv_mqa__geglu_ffn__prompt_kernel_poll3_ok
    s_waitcnt vmcnt(0)
    v_cmp_ne_u64 vcc, v[24:25], v[20:21]
    s_cmp_eq_u64 vcc, 0
    s_cbranch_scc1 gated_mix__grouped_kv_mqa__geglu_ffn__prompt_kernel_poll3_ok
    s_sleep 2
    s_branch gated_mix__grouped_kv_mqa__geglu_ffn__prompt_kernel_poll3
gated_mix__grouped_kv_mqa__geglu_ffn__prompt_kernel_poll3_ok:
gated_mix__grouped_kv_mqa__geglu_ffn__prompt_kernel_l_np2:
    s_mov_b64 exec, 1
    v_mov_b32 v22, 122880
    v_mov_b32 v9, 1
    s_waitcnt vmcnt(0)
    ds_add_u32 v22, v9 offset:12
    s_mov_b64 exec, -1
    s_and_b32 s52, s21, 3
    s_lshl_b32 s52, s52, 9
    s_add_u32 s35, s35, s52
    s_add_u32 s35, s35, 32768
    s_branch gated_mix__grouped_kv_mqa__geglu_ffn__prompt_kernel_p3
gated_mix__grouped_kv_mqa__geglu_ffn__prompt_kernel_comp:
    s_and_b32 s63, s22, 3
    s_lshr_b32 s64, s22, 2
    v_and_b32 v13, 31, v1
    v_lshrrev_b32 v14, 5, v1
    v_bfe_u32 v15, v1, 1, 3
    v_xor_b32 v2, v14, v15
    v_lshlrev_b32 v2, 4, v2
    v_lshl_add_u32 v2, v13, 7, v2
    s_lshl_b32 s52, s63, 13
    s_lshl_b32 s53, s64, 12
    s_add_u32 s52, s52, s53
    v_add_u32 v2, s52, v2
    v_xor_b32 v3, 32, v2
    v_xor_b32 v4, 64, v2
    v_xor_b32 v5, 96, v2
    v_bfe_u32 v15, v1, 2, 2
    v_lshlrev_b32 v7, 3, v14
    v_add_u32 v7, v7, v15
    v_mul_u32_u24 v9, 40, v7
    v_lshlrev_b32 v8, 6, v7
    v_lshlrev_b32 v7, 7, v7
    v_lshrrev_b32 v16, 1, v15
    v_xor_b32 v16, s64, v16
    v_lshl_add_u32 v7, v16, 6, v7
    v_bfe_u32 v16, v1, 4, 1
    v_and_b32 v17, 3, v1
    v_lshlrev_b32 v16, 5, v16
    v_lshl_add_u32 v16, v17, 3, v16
    v_add_u32 v7, v7, v16
    v_add_u32 v9, v9, v16
    v_cmp_eq_u32 vcc, 40, v16
    s_nop 1
    v_cndmask_b32 v16, v16, 48, vcc
    v_add_u32 v8, v8, v16
    v_add_u32 v7, 98304, v7
    v_add_u32 v8, 106496, v8
    v_add_u32 v9, 98304, v9
    s_mov_b32 s44, 0
    s_mov_b32 s45, 0
    s_mov_b32 s46, 0
    v_mov_b64 v[64:65], 0
    v_mov_b64 v[66:67], 0
    v_mov_b64 v[68:69], 0
    v_mov_b64 v[70:71], 0
    v_mov_b64 v[72:73], 0
    v_mov_b64 v[74:75], 0
    v_mov_b64 v[76:77], 0
    v_mov_b64 v[78:79], 0
    v_mov_b64 v[80:81], 0
    v_mov_b64 v[82:83], 0
    v_mov_b64 v[84:85], 0
    v_mov_b64 v[86:87], 0
    v_mov_b64 v[88:89], 0
    v_mov_b64 v[90:91], 0
    v_mov_b64 v[92:93], 0
    v_mov_b64 v[94:95], 0
    v_mov_b64 v[96:97], 0
    v_mov_b64 v[98:99], 0
    v_mov_b64 v[100:101], 0
    v_mov_b64 v[102:103], 0
    v_mov_b64 v[104:105], 0
    v_mov_b64 v[106:107], 0
    v_mov_b64 v[108:109], 0
    v_mov_b64 v[110:111], 0
    v_mov_b64 v[112:113], 0
    v_mov_b64 v[114:115], 0
    v_mov_b64 v[116:117], 0
    v_mov_b64 v[118:119], 0
    v_mov_b64 v[120:121], 0
    v_mov_b64 v[122:123], 0
    v_mov_b64 v[124:125], 0
    v_mov_b64 v[126:127], 0
    v_mov_b64 v[128:129], 0
    v_mov_b64 v[130:131], 0
    v_mov_b64 v[132:133], 0
    v_mov_b64 v[134:135], 0
    v_mov_b64 v[136:137], 0
    v_mov_b64 v[138:139], 0
    v_mov_b64 v[140:141], 0
    v_mov_b64 v[142:143], 0
    s_waitcnt lgkmcnt(0)
    s_mov_b32 s8, s18
    s_and_b32 s9, s19, 0xffff
    s_mov_b32 s10, 33554432
    s_mov_b32 s11, 0x20000
    s_or_b32 s52, s22, s2
    s_cmp_lg_u32 s52, 0
    s_cbranch_scc1 gated_mix__grouped_kv_mqa__geglu_ffn__prompt_kernel_nonon
    s_load_dwordx2 s[52:53], s[0:1], 88
    s_memrealtime s[54:55]
    v_mov_b32 v148, 0
    s_waitcnt lgkmcnt(0)
    s_or_b32 s54, s54, 1
    v_mov_b32 v144, s54
    v_mov_b32 v145, s55
    s_mov_b64 exec, 1
    global_store_dwordx2 v148, v[144:145], s[52:53] sc0 sc1
    s_mov_b64 exec, -1
gated_mix__grouped_kv_mqa__geglu_ffn__prompt_kernel_nonon:
    s_lshr_b32 s52, s21, 4
    s_xor_b32 s53, s22, 1
    s_or_b32 s52, s52, s53
    s_cmp_lg_u32 s52, 0
    s_cbranch_scc1 gated_mix__grouped_kv_mqa__geglu_ffn__prompt_kernel_noin
    s_lshl_b32 s52, s20, 5
    s_add_u32 s52, s52, s21
    s_lshl_b32 s52, s52, 7
    s_add_u32 s52, s52, 3506176
    s_mov_b64 exec, 1
    buffer_store_dword v64, v64, s[8:11], s52 offen sc1
    s_mov_b64 exec, -1
gated_mix__grouped_kv_mqa__geglu_ffn__prompt_kernel_noin:
    s_cmp_eq_u32 s21, 27
    s_cbranch_scc1 gated_mix__grouped_kv_mqa__geglu_ffn__prompt_kernel_modeK
    s_cmp_eq_u32 s21, 28
    s_cbranch_scc1 gated_mix__grouped_kv_mqa__geglu_ffn__prompt_kernel_modeV
    s_cmp_gt_u32 s21, 28
    s_cbranch_scc1 gated_mix__grouped_kv_mqa__geglu_ffn__prompt_kernel_modeQ
gated_mix__grouped_kv_mqa__geglu_ffn__prompt_kernel_full:
    v_add_u32 v56, s45, v2
    v_add_u32 v57, s45, v3
    v_add_u32 v58, s45, v4
    v_add_u32 v59, s45, v5
    v_xor_b32 v60, 4096, v56
    v_xor_b32 v61, 4096, v57
    v_xor_b32 v62, 4096, v58
    v_xor_b32 v63, 4096, v59
    s_add_u32 s45, s45, 32768
    s_cmp_ge_u32 s45, 98304
    s_cselect_b32 s45, 0, s45
    v_add_u32 v12, s44, v8
    v_add_u32 v11, s44, v7
    s_add_u32 s44, s44, 10240
    s_cmp_ge_u32 s44, 40960
    s_cselect_b32 s44, 0, s44
    s_barrier
    ds_read_b128 v[16:19], v56
    ds_read_b64_tr_b16 v[24:25], v11 offset:0
    ds_read_b64_tr_b16 v[26:27], v11 offset:512
    ds_read_b64_tr_b16 v[28:29], v11 offset:4096
    ds_read_b64_tr_b16 v[30:31], v11 offset:4608
    ds_read_b128 v[20:23], v60
    ds_read_b64_tr_b16 v[32:33], v12 offset:0
    ds_read_b64_tr_b16 v[34:35], v12 offset:256
.p2align 6
gated_mix__grouped_kv_mqa__geglu_ffn__prompt_kernel_full_loop:
    s_waitcnt lgkmcnt(2)
    v_mfma_f32_32x32x16_bf16 v[64:79], v[24:27], v[16:19], v[64:79]
    ds_read_b128 v[36:39], v57
    ds_read_b64_tr_b16 v[44:45], v11 offset:2048
    ds_read_b64_tr_b16 v[46:47], v11 offset:2560
    v_mfma_f32_32x32x16_bf16 v[80:95], v[28:31], v[16:19], v[80:95]
    ds_read_b64_tr_b16 v[48:49], v11 offset:6144
    ds_read_b64_tr_b16 v[50:51], v11 offset:6656
    ds_read_b128 v[40:43], v61
    v_mfma_f32_32x32x16_bf16 v[96:111], v[24:27], v[20:23], v[96:111]
    ds_read_b64_tr_b16 v[52:53], v12 offset:1024
    ds_read_b64_tr_b16 v[54:55], v12 offset:1280
    v_mfma_f32_32x32x16_bf16 v[112:127], v[28:31], v[20:23], v[112:127]
    v_add_u32 v12, s44, v8
    v_add_u32 v11, s44, v7
    s_add_u32 s44, s44, 10240
    s_cmp_ge_u32 s44, 40960
    s_cselect_b32 s44, 0, s44
    s_waitcnt lgkmcnt(8)
    v_mfma_f32_32x32x16_bf16 v[128:143], v[32:35], v[16:19], v[128:143]
    s_barrier
    s_waitcnt lgkmcnt(2)
    v_mfma_f32_32x32x16_bf16 v[64:79], v[44:47], v[36:39], v[64:79]
    ds_read_b128 v[16:19], v58
    ds_read_b64_tr_b16 v[24:25], v11 offset:0
    ds_read_b64_tr_b16 v[26:27], v11 offset:512
    v_mfma_f32_32x32x16_bf16 v[80:95], v[48:51], v[36:39], v[80:95]
    ds_read_b64_tr_b16 v[28:29], v11 offset:4096
    ds_read_b64_tr_b16 v[30:31], v11 offset:4608
    ds_read_b128 v[20:23], v62
    v_mfma_f32_32x32x16_bf16 v[96:111], v[44:47], v[40:43], v[96:111]
    ds_read_b64_tr_b16 v[32:33], v12 offset:0
    ds_read_b64_tr_b16 v[34:35], v12 offset:256
    v_mfma_f32_32x32x16_bf16 v[112:127], v[48:51], v[40:43], v[112:127]
    s_waitcnt lgkmcnt(8)
    v_mfma_f32_32x32x16_bf16 v[128:143], v[52:55], v[36:39], v[128:143]
    s_waitcnt lgkmcnt(2)
    v_mfma_f32_32x32x16_bf16 v[64:79], v[24:27], v[16:19], v[64:79]
    ds_read_b128 v[36:39], v59
    ds_read_b64_tr_b16 v[44:45], v11 offset:2048
    ds_read_b64_tr_b16 v[46:47], v11 offset:2560
    v_mfma_f32_32x32x16_bf16 v[80:95], v[28:31], v[16:19], v[80:95]
    ds_read_b64_tr_b16 v[48:49], v11 offset:6144
    ds_read_b64_tr_b16 v[50:51], v11 offset:6656
    ds_read_b128 v[40:43], v63
    v_mfma_f32_32x32x16_bf16 v[96:111], v[24:27], v[20:23], v[96:111]
    ds_read_b64_tr_b16 v[52:53], v12 offset:1024
    ds_read_b64_tr_b16 v[54:55], v12 offset:1280
    v_mfma_f32_32x32x16_bf16 v[112:127], v[28:31], v[20:23], v[112:127]
    v_add_u32 v12, s44, v8
    v_add_u32 v11, s44, v7
    s_add_u32 s44, s44, 10240
    s_cmp_ge_u32 s44, 40960
    s_cselect_b32 s44, 0, s44
    v_add_u32 v56, s45, v2
    v_add_u32 v57, s45, v3
    v_add_u32 v58, s45, v4
    v_add_u32 v59, s45, v5
    v_xor_b32 v60, 4096, v56
    v_xor_b32 v61, 4096, v57
    v_xor_b32 v62, 4096, v58
    v_xor_b32 v63, 4096, v59
    s_add_u32 s45, s45, 32768
    s_cmp_ge_u32 s45, 98304
    s_cselect_b32 s45, 0, s45
    s_waitcnt lgkmcnt(8)
    v_mfma_f32_32x32x16_bf16 v[128:143], v[32:35], v[16:19], v[128:143]
    s_barrier
    s_waitcnt lgkmcnt(2)
    v_mfma_f32_32x32x16_bf16 v[64:79], v[44:47], v[36:39], v[64:79]
    ds_read_b128 v[16:19], v56
    ds_read_b64_tr_b16 v[24:25], v11 offset:0
    ds_read_b64_tr_b16 v[26:27], v11 offset:512
    v_mfma_f32_32x32x16_bf16 v[80:95], v[48:51], v[36:39], v[80:95]
    ds_read_b64_tr_b16 v[28:29], v11 offset:4096
    ds_read_b64_tr_b16 v[30:31], v11 offset:4608
    ds_read_b128 v[20:23], v60
    v_mfma_f32_32x32x16_bf16 v[96:111], v[44:47], v[40:43], v[96:111]
    ds_read_b64_tr_b16 v[32:33], v12 offset:0
    ds_read_b64_tr_b16 v[34:35], v12 offset:256
    v_mfma_f32_32x32x16_bf16 v[112:127], v[48:51], v[40:43], v[112:127]
    s_add_u32 s46, s46, 1
    s_cmp_lt_u32 s46, 10
    s_waitcnt lgkmcnt(8)
    v_mfma_f32_32x32x16_bf16 v[128:143], v[52:55], v[36:39], v[128:143]
    s_cbranch_scc1 gated_mix__grouped_kv_mqa__geglu_ffn__prompt_kernel_full_loop
    s_lshl_b32 s52, s20, 3
    s_lshl_b32 s53, s63, 1
    s_add_u32 s52, s52, s53
    s_add_u32 s52, s52, s64
    v_lshlrev_b32 v2, 4, v1
    s_branch gated_mix__grouped_kv_mqa__geglu_ffn__prompt_kernel_epi0
gated_mix__grouped_kv_mqa__geglu_ffn__prompt_kernel_modeK:
    v_add_u32 v56, s45, v2
    v_add_u32 v57, s45, v3
    v_add_u32 v58, s45, v4
    v_add_u32 v59, s45, v5
    s_add_u32 s45, s45, 32768
    s_cmp_ge_u32 s45, 98304
    s_cselect_b32 s45, 0, s45
    v_add_u32 v12, s44, v8
    v_add_u32 v11, s44, v9
    s_add_u32 s44, s44, 10240
    s_cmp_ge_u32 s44, 40960
    s_cselect_b32 s44, 0, s44
    s_barrier
    ds_read_b128 v[16:19], v56
    ds_read_b64_tr_b16 v[24:25], v11 offset:0
    ds_read_b64_tr_b16 v[26:27], v11 offset:160
    ds_read_b64_tr_b16 v[32:33], v12 offset:0
    ds_read_b64_tr_b16 v[34:35], v12 offset:256
gated_mix__grouped_kv_mqa__geglu_ffn__prompt_kernel_modeK_loop:
    s_waitcnt lgkmcnt(0)
    v_mfma_f32_32x32x16_bf16 v[64:79], v[24:27], v[16:19], v[64:79]
    ds_read_b128 v[36:39], v57
    ds_read_b64_tr_b16 v[44:45], v11 offset:640
    ds_read_b64_tr_b16 v[46:47], v11 offset:800
    ds_read_b64_tr_b16 v[52:53], v12 offset:1024
    ds_read_b64_tr_b16 v[54:55], v12 offset:1280
    v_add_u32 v12, s44, v8
    v_add_u32 v11, s44, v9
    s_add_u32 s44, s44, 10240
    s_cmp_ge_u32 s44, 40960
    s_cselect_b32 s44, 0, s44
    v_mfma_f32_32x32x16_bf16 v[128:143], v[32:35], v[16:19], v[128:143]
    s_barrier
    s_waitcnt lgkmcnt(0)
    v_mfma_f32_32x32x16_bf16 v[64:79], v[44:47], v[36:39], v[64:79]
    ds_read_b128 v[16:19], v58
    ds_read_b64_tr_b16 v[24:25], v11 offset:0
    ds_read_b64_tr_b16 v[26:27], v11 offset:160
    ds_read_b64_tr_b16 v[32:33], v12 offset:0
    ds_read_b64_tr_b16 v[34:35], v12 offset:256
    v_mfma_f32_32x32x16_bf16 v[128:143], v[52:55], v[36:39], v[128:143]
    s_waitcnt lgkmcnt(0)
    v_mfma_f32_32x32x16_bf16 v[64:79], v[24:27], v[16:19], v[64:79]
    ds_read_b128 v[36:39], v59
    ds_read_b64_tr_b16 v[44:45], v11 offset:640
    ds_read_b64_tr_b16 v[46:47], v11 offset:800
    ds_read_b64_tr_b16 v[52:53], v12 offset:1024
    ds_read_b64_tr_b16 v[54:55], v12 offset:1280
    v_add_u32 v12, s44, v8
    v_add_u32 v11, s44, v9
    s_add_u32 s44, s44, 10240
    s_cmp_ge_u32 s44, 40960
    s_cselect_b32 s44, 0, s44
    v_add_u32 v56, s45, v2
    v_add_u32 v57, s45, v3
    v_add_u32 v58, s45, v4
    v_add_u32 v59, s45, v5
    s_add_u32 s45, s45, 32768
    s_cmp_ge_u32 s45, 98304
    s_cselect_b32 s45, 0, s45
    v_mfma_f32_32x32x16_bf16 v[128:143], v[32:35], v[16:19], v[128:143]
    s_barrier
    s_waitcnt lgkmcnt(0)
    v_mfma_f32_32x32x16_bf16 v[64:79], v[44:47], v[36:39], v[64:79]
    ds_read_b128 v[16:19], v56
    ds_read_b64_tr_b16 v[24:25], v11 offset:0
    ds_read_b64_tr_b16 v[26:27], v11 offset:160
    ds_read_b64_tr_b16 v[32:33], v12 offset:0
    ds_read_b64_tr_b16 v[34:35], v12 offset:256
    s_add_u32 s46, s46, 1
    s_cmp_lt_u32 s46, 10
    v_mfma_f32_32x32x16_bf16 v[128:143], v[52:55], v[36:39], v[128:143]
    s_cbranch_scc1 gated_mix__grouped_kv_mqa__geglu_ffn__prompt_kernel_modeK_loop
    s_lshl_b32 s52, s20, 3
    s_lshl_b32 s53, s63, 1
    s_add_u32 s52, s52, s53
    s_add_u32 s52, s52, s64
    v_lshlrev_b32 v2, 4, v1
    s_branch gated_mix__grouped_kv_mqa__geglu_ffn__prompt_kernel_epi1
gated_mix__grouped_kv_mqa__geglu_ffn__prompt_kernel_modeV:
    v_add_u32 v56, s45, v2
    v_add_u32 v57, s45, v3
    v_add_u32 v58, s45, v4
    v_add_u32 v59, s45, v5
    s_add_u32 s45, s45, 32768
    s_cmp_ge_u32 s45, 98304
    s_cselect_b32 s45, 0, s45
    v_add_u32 v12, s44, v8
    v_add_u32 v11, s44, v9
    s_add_u32 s44, s44, 10240
    s_cmp_ge_u32 s44, 40960
    s_cselect_b32 s44, 0, s44
    s_barrier
    ds_read_b128 v[16:19], v56
    ds_read_b64_tr_b16 v[24:25], v11 offset:0
    ds_read_b64_tr_b16 v[26:27], v11 offset:160
    ds_read_b64_tr_b16 v[32:33], v12 offset:0
    ds_read_b64_tr_b16 v[34:35], v12 offset:256
gated_mix__grouped_kv_mqa__geglu_ffn__prompt_kernel_modeV_loop:
    s_waitcnt lgkmcnt(0)
    v_mfma_f32_32x32x16_bf16 v[64:79], v[16:19], v[24:27], v[64:79]
    ds_read_b128 v[36:39], v57
    ds_read_b64_tr_b16 v[44:45], v11 offset:640
    ds_read_b64_tr_b16 v[46:47], v11 offset:800
    ds_read_b64_tr_b16 v[52:53], v12 offset:1024
    ds_read_b64_tr_b16 v[54:55], v12 offset:1280
    v_add_u32 v12, s44, v8
    v_add_u32 v11, s44, v9
    s_add_u32 s44, s44, 10240
    s_cmp_ge_u32 s44, 40960
    s_cselect_b32 s44, 0, s44
    v_mfma_f32_32x32x16_bf16 v[128:143], v[32:35], v[16:19], v[128:143]
    s_barrier
    s_waitcnt lgkmcnt(0)
    v_mfma_f32_32x32x16_bf16 v[64:79], v[36:39], v[44:47], v[64:79]
    ds_read_b128 v[16:19], v58
    ds_read_b64_tr_b16 v[24:25], v11 offset:0
    ds_read_b64_tr_b16 v[26:27], v11 offset:160
    ds_read_b64_tr_b16 v[32:33], v12 offset:0
    ds_read_b64_tr_b16 v[34:35], v12 offset:256
    v_mfma_f32_32x32x16_bf16 v[128:143], v[52:55], v[36:39], v[128:143]
    s_waitcnt lgkmcnt(0)
    v_mfma_f32_32x32x16_bf16 v[64:79], v[16:19], v[24:27], v[64:79]
    ds_read_b128 v[36:39], v59
    ds_read_b64_tr_b16 v[44:45], v11 offset:640
    ds_read_b64_tr_b16 v[46:47], v11 offset:800
    ds_read_b64_tr_b16 v[52:53], v12 offset:1024
    ds_read_b64_tr_b16 v[54:55], v12 offset:1280
    v_add_u32 v12, s44, v8
    v_add_u32 v11, s44, v9
    s_add_u32 s44, s44, 10240
    s_cmp_ge_u32 s44, 40960
    s_cselect_b32 s44, 0, s44
    v_add_u32 v56, s45, v2
    v_add_u32 v57, s45, v3
    v_add_u32 v58, s45, v4
    v_add_u32 v59, s45, v5
    s_add_u32 s45, s45, 32768
    s_cmp_ge_u32 s45, 98304
    s_cselect_b32 s45, 0, s45
    v_mfma_f32_32x32x16_bf16 v[128:143], v[32:35], v[16:19], v[128:143]
    s_barrier
    s_waitcnt lgkmcnt(0)
    v_mfma_f32_32x32x16_bf16 v[64:79], v[36:39], v[44:47], v[64:79]
    ds_read_b128 v[16:19], v56
    ds_read_b64_tr_b16 v[24:25], v11 offset:0
    ds_read_b64_tr_b16 v[26:27], v11 offset:160
    ds_read_b64_tr_b16 v[32:33], v12 offset:0
    ds_read_b64_tr_b16 v[34:35], v12 offset:256
    s_add_u32 s46, s46, 1
    s_cmp_lt_u32 s46, 10
    v_mfma_f32_32x32x16_bf16 v[128:143], v[52:55], v[36:39], v[128:143]
    s_cbranch_scc1 gated_mix__grouped_kv_mqa__geglu_ffn__prompt_kernel_modeV_loop
    s_lshl_b32 s52, s20, 3
    s_lshl_b32 s53, s63, 1
    s_add_u32 s52, s52, s53
    s_add_u32 s52, s52, s64
    v_lshlrev_b32 v2, 4, v1
    s_branch gated_mix__grouped_kv_mqa__geglu_ffn__prompt_kernel_epi2
gated_mix__grouped_kv_mqa__geglu_ffn__prompt_kernel_modeQ:
    v_add_u32 v56, s45, v2
    v_add_u32 v57, s45, v3
    v_add_u32 v58, s45, v4
    v_add_u32 v59, s45, v5
    s_add_u32 s45, s45, 32768
    s_cmp_ge_u32 s45, 98304
    s_cselect_b32 s45, 0, s45
    v_add_u32 v12, s44, v8
    s_add_u32 s44, s44, 10240
    s_cmp_ge_u32 s44, 40960
    s_cselect_b32 s44, 0, s44
    s_barrier
    ds_read_b128 v[16:19], v56
    ds_read_b64_tr_b16 v[32:33], v12 offset:0
    ds_read_b64_tr_b16 v[34:35], v12 offset:256
gated_mix__grouped_kv_mqa__geglu_ffn__prompt_kernel_modeQ_loop:
    s_waitcnt lgkmcnt(0)
    v_mfma_f32_32x32x16_bf16 v[128:143], v[32:35], v[16:19], v[128:143]
    ds_read_b128 v[36:39], v57
    ds_read_b64_tr_b16 v[52:53], v12 offset:1024
    ds_read_b64_tr_b16 v[54:55], v12 offset:1280
    v_add_u32 v12, s44, v8
    s_add_u32 s44, s44, 10240
    s_cmp_ge_u32 s44, 40960
    s_cselect_b32 s44, 0, s44
    s_barrier
    s_waitcnt lgkmcnt(0)
    v_mfma_f32_32x32x16_bf16 v[128:143], v[52:55], v[36:39], v[128:143]
    ds_read_b128 v[16:19], v58
    ds_read_b64_tr_b16 v[32:33], v12 offset:0
    ds_read_b64_tr_b16 v[34:35], v12 offset:256
    s_waitcnt lgkmcnt(0)
    v_mfma_f32_32x32x16_bf16 v[128:143], v[32:35], v[16:19], v[128:143]
    ds_read_b128 v[36:39], v59
    ds_read_b64_tr_b16 v[52:53], v12 offset:1024
    ds_read_b64_tr_b16 v[54:55], v12 offset:1280
    v_add_u32 v12, s44, v8
    s_add_u32 s44, s44, 10240
    s_cmp_ge_u32 s44, 40960
    s_cselect_b32 s44, 0, s44
    v_add_u32 v56, s45, v2
    v_add_u32 v57, s45, v3
    v_add_u32 v58, s45, v4
    v_add_u32 v59, s45, v5
    s_add_u32 s45, s45, 32768
    s_cmp_ge_u32 s45, 98304
    s_cselect_b32 s45, 0, s45
    s_barrier
    s_waitcnt lgkmcnt(0)
    v_mfma_f32_32x32x16_bf16 v[128:143], v[52:55], v[36:39], v[128:143]
    ds_read_b128 v[16:19], v56
    ds_read_b64_tr_b16 v[32:33], v12 offset:0
    ds_read_b64_tr_b16 v[34:35], v12 offset:256
    s_add_u32 s46, s46, 1
    s_cmp_lt_u32 s46, 10
    s_cbranch_scc1 gated_mix__grouped_kv_mqa__geglu_ffn__prompt_kernel_modeQ_loop
    s_lshl_b32 s52, s20, 3
    s_lshl_b32 s53, s63, 1
    s_add_u32 s52, s52, s53
    s_add_u32 s52, s52, s64
    v_lshlrev_b32 v2, 4, v1
    s_branch gated_mix__grouped_kv_mqa__geglu_ffn__prompt_kernel_epi3
gated_mix__grouped_kv_mqa__geglu_ffn__prompt_kernel_epi1:
    s_mul_i32 s53, s52, 3072
    s_add_u32 s53, s53, 3145728
    s_nop 7
    s_waitcnt lgkmcnt(0)
    v_cvt_pk_bf16_f32 v20, v64, v65
    v_cvt_pk_bf16_f32 v21, v66, v67
    v_cvt_pk_bf16_f32 v22, v68, v69
    v_cvt_pk_bf16_f32 v23, v70, v71
    buffer_store_dwordx4 v[20:23], v2, s[8:11], s53 offen sc1
    v_cvt_pk_bf16_f32 v24, v72, v73
    v_cvt_pk_bf16_f32 v25, v74, v75
    v_mov_b32 v26, 0x3f803f80
    v_mov_b32 v27, 0x00003f80
    v_mul_f32 v30, v64, v64
    v_fmac_f32 v30, v65, v65
    v_fmac_f32 v30, v66, v66
    v_fmac_f32 v30, v67, v67
    v_fmac_f32 v30, v68, v68
    v_fmac_f32 v30, v69, v69
    v_fmac_f32 v30, v70, v70
    v_fmac_f32 v30, v71, v71
    v_mul_f32 v31, v72, v72
    v_fmac_f32 v31, v73, v73
    v_fmac_f32 v31, v74, v74
    v_fmac_f32 v31, v75, v75
    v_cmp_gt_u32 vcc, 32, v1
    s_nop 1
    v_cndmask_b32 v31, 0, v31, vcc
    v_add_f32 v30, v30, v31
    v_mov_b32 v31, v30
    s_nop 1
    v_permlane32_swap_b32 v30, v31
    s_nop 1
    v_add_f32 v30, v30, v31
    s_nop 1
    v_max_f32_dpp v30, v30, v30 row_shr:1 row_mask:0xf bank_mask:0xf
    s_nop 1
    v_max_f32_dpp v30, v30, v30 row_shr:2 row_mask:0xf bank_mask:0xf
    s_nop 1
    v_max_f32_dpp v30, v30, v30 row_shr:4 row_mask:0xf bank_mask:0xf
    s_nop 1
    v_max_f32_dpp v30, v30, v30 row_shr:8 row_mask:0xf bank_mask:0xf
    s_nop 1
    v_max_f32_dpp v30, v30, v30 row_bcast:15 row_mask:0xa bank_mask:0xf
    v_cmp_eq_u32 vcc, 63, v1
    v_and_b32 v30, 0xffff0000, v30
    v_or_b32 v30, 0x3f80, v30
    v_cndmask_b32 v27, v27, v30, vcc
    v_cmp_gt_u32 vcc, 32, v1
    v_lshlrev_b32 v16, 3, v1
    s_nop 0
    v_cndmask_b32 v24, v26, v24, vcc
    v_cndmask_b32 v25, v27, v25, vcc
    buffer_store_dwordx2 v[24:25], v16, s[8:11], s53 offen offset:1024 sc1
    s_branch gated_mix__grouped_kv_mqa__geglu_ffn__prompt_kernel_kvdone
gated_mix__grouped_kv_mqa__geglu_ffn__prompt_kernel_epi2:
    s_mul_i32 s53, s52, 3072
    s_add_u32 s53, s53, 3147264
    v_and_b32 v17, 31, v1
    v_lshrrev_b32 v18, 5, v1
    v_mul_u32_u24 v18, 384, v18
    v_lshl_add_u32 v16, v17, 4, v18
    v_mov_b32 v19, 0x3f803f80
    v_cmp_eq_u32 vcc, 20, v17
    v_cmp_lt_u32 s[54:55], 19, v17
    s_nop 3
    v_cndmask_b32 v19, 0, v19, vcc
    s_waitcnt lgkmcnt(0)
    v_cvt_pk_bf16_f32 v20, v64, v65
    v_cvt_pk_bf16_f32 v21, v66, v67
    v_cvt_pk_bf16_f32 v22, v68, v69
    v_cvt_pk_bf16_f32 v23, v70, v71
    v_cvt_pk_bf16_f32 v24, v72, v73
    v_cvt_pk_bf16_f32 v25, v74, v75
    v_cvt_pk_bf16_f32 v26, v76, v77
    v_cvt_pk_bf16_f32 v27, v78, v79
    v_cndmask_b32 v20, v20, v19, s[54:55]
    v_cndmask_b32 v21, v21, v19, s[54:55]
    v_cndmask_b32 v22, v22, v19, s[54:55]
    v_cndmask_b32 v23, v23, v19, s[54:55]
    v_cndmask_b32 v24, v24, v19, s[54:55]
    v_cndmask_b32 v25, v25, v19, s[54:55]
    v_cndmask_b32 v26, v26, v19, s[54:55]
    v_cndmask_b32 v27, v27, v19, s[54:55]
    v_cmp_gt_u32 vcc, 24, v17
    s_nop 1
    s_and_b64 exec, exec, vcc
    buffer_store_dwordx4 v[20:23], v16, s[8:11], s53 offen sc1
    buffer_store_dwordx4 v[24:27], v16, s[8:11], s53 offen offset:768 sc1
gated_mix__grouped_kv_mqa__geglu_ffn__prompt_kernel_kvdone:
    s_mov_b64 exec, -1
    s_waitcnt vmcnt(0)
    s_barrier
    s_branch gated_mix__grouped_kv_mqa__geglu_ffn__prompt_kernel_epi3
gated_mix__grouped_kv_mqa__geglu_ffn__prompt_kernel_epi0:
    v_mov_b32 v16, 0xc0135761
    v_mov_b32 v17, 0xc0135761
    v_mov_b32 v18, 0xbdd2d3e8
    v_mov_b32 v19, 0xbdd2d3e8
    v_mov_b32 v44, 1.0
    v_mov_b32 v45, 1.0
    s_and_b32 s54, s21, 3
    s_mul_i32 s54, s54, 7
    s_add_u32 s54, s54, s68
    s_lshl_b32 s54, s54, 12
    s_lshl_b32 s55, s64, 11
    s_add_u32 s54, s54, s55
    s_add_u32 s54, s54, 4194304
    s_mul_i32 s53, s52, 110592
    s_add_u32 s53, s53, s54
    s_xor_b32 s55, s52, 1
    s_mul_i32 s55, s55, 110592
    s_add_u32 s54, s54, s55
    s_waitcnt lgkmcnt(0)
    v_pk_mul_f32 v[20:21], v[64:65], v[64:65]
    v_pk_mul_f32 v[22:23], v[66:67], v[66:67]
    v_pk_mul_f32 v[24:25], v[68:69], v[68:69]
    v_pk_mul_f32 v[26:27], v[70:71], v[70:71]
    v_pk_fma_f32 v[20:21], v[20:21], v[18:19], v[16:17]
    v_pk_fma_f32 v[22:23], v[22:23], v[18:19], v[16:17]
    v_pk_fma_f32 v[24:25], v[24:25], v[18:19], v[16:17]
    v_pk_fma_f32 v[26:27], v[26:27], v[18:19], v[16:17]
    v_pk_mul_f32 v[20:21], v[64:65], v[20:21]
    v_pk_mul_f32 v[22:23], v[66:67], v[22:23]
    v_pk_mul_f32 v[24:25], v[68:69], v[24:25]
    v_pk_mul_f32 v[26:27], v[70:71], v[26:27]
    v_exp_f32 v20, v20
    v_exp_f32 v21, v21
    v_exp_f32 v22, v22
    v_exp_f32 v23, v23
    v_exp_f32 v24, v24
    v_exp_f32 v25, v25
    v_exp_f32 v26, v26
    v_exp_f32 v27, v27
    v_pk_mul_f32 v[80:81], v[64:65], v[80:81]
    v_pk_mul_f32 v[82:83], v[66:67], v[82:83]
    v_pk_mul_f32 v[84:85], v[68:69], v[84:85]
    v_pk_mul_f32 v[86:87], v[70:71], v[86:87]
    v_pk_add_f32 v[20:21], v[20:21], v[44:45]
    v_pk_add_f32 v[22:23], v[22:23], v[44:45]
    v_pk_add_f32 v[24:25], v[24:25], v[44:45]
    v_pk_add_f32 v[26:27], v[26:27], v[44:45]
    v_rcp_f32 v20, v20
    v_rcp_f32 v21, v21
    v_rcp_f32 v22, v22
    v_rcp_f32 v23, v23
    v_rcp_f32 v24, v24
    v_rcp_f32 v25, v25
    v_rcp_f32 v26, v26
    v_rcp_f32 v27, v27
    s_nop 0
    v_pk_mul_f32 v[20:21], v[80:81], v[20:21]
    v_pk_mul_f32 v[22:23], v[82:83], v[22:23]
    v_pk_mul_f32 v[24:25], v[84:85], v[24:25]
    v_pk_mul_f32 v[26:27], v[86:87], v[26:27]
    v_cvt_pk_bf16_f32 v28, v20, v21
    v_cvt_pk_bf16_f32 v29, v22, v23
    v_cvt_pk_bf16_f32 v30, v24, v25
    v_cvt_pk_bf16_f32 v31, v26, v27
    buffer_store_dwordx4 v[28:31], v2, s[8:11], s53 offen offset:0 sc1
    v_pk_mul_f32 v[20:21], v[72:73], v[72:73]
    v_pk_mul_f32 v[22:23], v[74:75], v[74:75]
    v_pk_mul_f32 v[24:25], v[76:77], v[76:77]
    v_pk_mul_f32 v[26:27], v[78:79], v[78:79]
    v_pk_fma_f32 v[20:21], v[20:21], v[18:19], v[16:17]
    v_pk_fma_f32 v[22:23], v[22:23], v[18:19], v[16:17]
    v_pk_fma_f32 v[24:25], v[24:25], v[18:19], v[16:17]
    v_pk_fma_f32 v[26:27], v[26:27], v[18:19], v[16:17]
    v_pk_mul_f32 v[20:21], v[72:73], v[20:21]
    v_pk_mul_f32 v[22:23], v[74:75], v[22:23]
    v_pk_mul_f32 v[24:25], v[76:77], v[24:25]
    v_pk_mul_f32 v[26:27], v[78:79], v[26:27]
    v_exp_f32 v20, v20
    v_exp_f32 v21, v21
    v_exp_f32 v22, v22
    v_exp_f32 v23, v23
    v_exp_f32 v24, v24
    v_exp_f32 v25, v25
    v_exp_f32 v26, v26
    v_exp_f32 v27, v27
    v_pk_mul_f32 v[88:89], v[72:73], v[88:89]
    v_pk_mul_f32 v[90:91], v[74:75], v[90:91]
    v_pk_mul_f32 v[92:93], v[76:77], v[92:93]
    v_pk_mul_f32 v[94:95], v[78:79], v[94:95]
    v_pk_add_f32 v[20:21], v[20:21], v[44:45]
    v_pk_add_f32 v[22:23], v[22:23], v[44:45]
    v_pk_add_f32 v[24:25], v[24:25], v[44:45]
    v_pk_add_f32 v[26:27], v[26:27], v[44:45]
    v_rcp_f32 v20, v20
    v_rcp_f32 v21, v21
    v_rcp_f32 v22, v22
    v_rcp_f32 v23, v23
    v_rcp_f32 v24, v24
    v_rcp_f32 v25, v25
    v_rcp_f32 v26, v26
    v_rcp_f32 v27, v27
    s_nop 0
    v_pk_mul_f32 v[20:21], v[88:89], v[20:21]
    v_pk_mul_f32 v[22:23], v[90:91], v[22:23]
    v_pk_mul_f32 v[24:25], v[92:93], v[24:25]
    v_pk_mul_f32 v[26:27], v[94:95], v[26:27]
    v_cvt_pk_bf16_f32 v32, v20, v21
    v_cvt_pk_bf16_f32 v33, v22, v23
    v_cvt_pk_bf16_f32 v34, v24, v25
    v_cvt_pk_bf16_f32 v35, v26, v27
    buffer_store_dwordx4 v[32:35], v2, s[8:11], s53 offen offset:1024 sc1
    v_pk_mul_f32 v[20:21], v[96:97], v[96:97]
    v_pk_mul_f32 v[22:23], v[98:99], v[98:99]
    v_pk_mul_f32 v[24:25], v[100:101], v[100:101]
    v_pk_mul_f32 v[26:27], v[102:103], v[102:103]
    v_pk_fma_f32 v[20:21], v[20:21], v[18:19], v[16:17]
    v_pk_fma_f32 v[22:23], v[22:23], v[18:19], v[16:17]
    v_pk_fma_f32 v[24:25], v[24:25], v[18:19], v[16:17]
    v_pk_fma_f32 v[26:27], v[26:27], v[18:19], v[16:17]
    v_pk_mul_f32 v[20:21], v[96:97], v[20:21]
    v_pk_mul_f32 v[22:23], v[98:99], v[22:23]
    v_pk_mul_f32 v[24:25], v[100:101], v[24:25]
    v_pk_mul_f32 v[26:27], v[102:103], v[26:27]
    v_exp_f32 v20, v20
    v_exp_f32 v21, v21
    v_exp_f32 v22, v22
    v_exp_f32 v23, v23
    v_exp_f32 v24, v24
    v_exp_f32 v25, v25
    v_exp_f32 v26, v26
    v_exp_f32 v27, v27
    v_pk_mul_f32 v[112:113], v[96:97], v[112:113]
    v_pk_mul_f32 v[114:115], v[98:99], v[114:115]
    v_pk_mul_f32 v[116:117], v[100:101], v[116:117]
    v_pk_mul_f32 v[118:119], v[102:103], v[118:119]
    v_pk_add_f32 v[20:21], v[20:21], v[44:45]
    v_pk_add_f32 v[22:23], v[22:23], v[44:45]
    v_pk_add_f32 v[24:25], v[24:25], v[44:45]
    v_pk_add_f32 v[26:27], v[26:27], v[44:45]
    v_rcp_f32 v20, v20
    v_rcp_f32 v21, v21
    v_rcp_f32 v22, v22
    v_rcp_f32 v23, v23
    v_rcp_f32 v24, v24
    v_rcp_f32 v25, v25
    v_rcp_f32 v26, v26
    v_rcp_f32 v27, v27
    s_nop 0
    v_pk_mul_f32 v[20:21], v[112:113], v[20:21]
    v_pk_mul_f32 v[22:23], v[114:115], v[22:23]
    v_pk_mul_f32 v[24:25], v[116:117], v[24:25]
    v_pk_mul_f32 v[26:27], v[118:119], v[26:27]
    v_cvt_pk_bf16_f32 v36, v20, v21
    v_cvt_pk_bf16_f32 v37, v22, v23
    v_cvt_pk_bf16_f32 v38, v24, v25
    v_cvt_pk_bf16_f32 v39, v26, v27
    buffer_store_dwordx4 v[36:39], v2, s[8:11], s54 offen offset:0 sc1
    v_pk_mul_f32 v[20:21], v[104:105], v[104:105]
    v_pk_mul_f32 v[22:23], v[106:107], v[106:107]
    v_pk_mul_f32 v[24:25], v[108:109], v[108:109]
    v_pk_mul_f32 v[26:27], v[110:111], v[110:111]
    v_pk_fma_f32 v[20:21], v[20:21], v[18:19], v[16:17]
    v_pk_fma_f32 v[22:23], v[22:23], v[18:19], v[16:17]
    v_pk_fma_f32 v[24:25], v[24:25], v[18:19], v[16:17]
    v_pk_fma_f32 v[26:27], v[26:27], v[18:19], v[16:17]
    v_pk_mul_f32 v[20:21], v[104:105], v[20:21]
    v_pk_mul_f32 v[22:23], v[106:107], v[22:23]
    v_pk_mul_f32 v[24:25], v[108:109], v[24:25]
    v_pk_mul_f32 v[26:27], v[110:111], v[26:27]
    v_exp_f32 v20, v20
    v_exp_f32 v21, v21
    v_exp_f32 v22, v22
    v_exp_f32 v23, v23
    v_exp_f32 v24, v24
    v_exp_f32 v25, v25
    v_exp_f32 v26, v26
    v_exp_f32 v27, v27
    v_pk_mul_f32 v[120:121], v[104:105], v[120:121]
    v_pk_mul_f32 v[122:123], v[106:107], v[122:123]
    v_pk_mul_f32 v[124:125], v[108:109], v[124:125]
    v_pk_mul_f32 v[126:127], v[110:111], v[126:127]
    v_pk_add_f32 v[20:21], v[20:21], v[44:45]
    v_pk_add_f32 v[22:23], v[22:23], v[44:45]
    v_pk_add_f32 v[24:25], v[24:25], v[44:45]
    v_pk_add_f32 v[26:27], v[26:27], v[44:45]
    v_rcp_f32 v20, v20
    v_rcp_f32 v21, v21
    v_rcp_f32 v22, v22
    v_rcp_f32 v23, v23
    v_rcp_f32 v24, v24
    v_rcp_f32 v25, v25
    v_rcp_f32 v26, v26
    v_rcp_f32 v27, v27
    s_nop 0
    v_pk_mul_f32 v[20:21], v[120:121], v[20:21]
    v_pk_mul_f32 v[22:23], v[122:123], v[22:23]
    v_pk_mul_f32 v[24:25], v[124:125], v[24:25]
    v_pk_mul_f32 v[26:27], v[126:127], v[26:27]
    v_cvt_pk_bf16_f32 v40, v20, v21
    v_cvt_pk_bf16_f32 v41, v22, v23
    v_cvt_pk_bf16_f32 v42, v24, v25
    v_cvt_pk_bf16_f32 v43, v26, v27
    buffer_store_dwordx4 v[40:43], v2, s[8:11], s54 offen offset:1024 sc1
gated_mix__grouped_kv_mqa__geglu_ffn__prompt_kernel_epi3:
    s_nop 7
    v_mov_b32 v144, 0x3ea52b5c
    v_mov_b32 v145, 0x3ea52b5c
    s_waitcnt lgkmcnt(0)
    v_pk_mul_f32 v[128:129], v[144:145], v[128:129]
    v_pk_mul_f32 v[130:131], v[144:145], v[130:131]
    v_pk_mul_f32 v[132:133], v[144:145], v[132:133]
    v_pk_mul_f32 v[134:135], v[144:145], v[134:135]
    v_pk_mul_f32 v[136:137], v[144:145], v[136:137]
    v_pk_mul_f32 v[138:139], v[144:145], v[138:139]
    v_cvt_pk_bf16_f32 v12, v128, v129
    v_cvt_pk_bf16_f32 v13, v130, v131
    v_cvt_pk_bf16_f32 v14, v132, v133
    v_cvt_pk_bf16_f32 v15, v134, v135
    v_cvt_pk_bf16_f32 v16, v136, v137
    v_cvt_pk_bf16_f32 v17, v138, v139
    s_mul_i32 s52, s63, 1536
    s_add_u32 s52, s52, 98304
    v_add_u32 v144, s52, v2
    v_lshl_add_u32 v145, v1, 3, s52
    s_cmp_ge_u32 s22, 4
    s_cbranch_scc1 gated_mix__grouped_kv_mqa__geglu_ffn__prompt_kernel_gwave
    s_setprio 1
    v_and_b32 v9, 31, v1
    v_lshrrev_b32 v10, 5, v1
    v_add_u32 v3, 126976, v2
    v_lshlrev_b32 v4, 3, v1
    v_add_u32 v4, 128000, v4
    v_min_u32 v5, 23, v9
    v_mul_u32_u24 v11, 384, v10
    v_lshl_add_u32 v5, v5, 4, v11
    v_add_u32 v5, 128512, v5
    v_lshlrev_b32 v146, 2, v1
    v_add_u32 v146, 32768, v146
    s_mov_b32 s27, 0
    s_mov_b32 s30, 0
    v_cmp_gt_u32 s[28:29], 32, v1
    v_lshlrev_b32 v60, 3, v9
    v_lshl_add_u32 v60, v10, 8, v60
    s_lshl_b32 s33, s20, 3
    s_lshl_b32 s52, s22, 1
    s_add_u32 s33, s33, s52
    s_mul_i32 s33, s33, 40960
    s_mul_i32 s52, s21, 1280
    s_add_u32 s33, s33, s52
    s_add_u32 s33, s33, 12582912
    s_add_u32 s31, s33, 40960
    v_mov_b64 v[96:97], 0
    v_mov_b64 v[98:99], 0
    v_mov_b64 v[100:101], 0
    v_mov_b64 v[102:103], 0
    v_mov_b64 v[104:105], 0
    v_mov_b64 v[106:107], 0
    v_mov_b64 v[108:109], 0
    v_mov_b64 v[110:111], 0
    v_mov_b64 v[112:113], 0
    v_mov_b64 v[114:115], 0
    v_mov_b64 v[116:117], 0
    v_mov_b64 v[118:119], 0
    v_mov_b64 v[120:121], 0
    v_mov_b64 v[122:123], 0
    v_mov_b64 v[124:125], 0
    v_mov_b64 v[126:127], 0
    v_mov_b64 v[136:137], 0
    v_mov_b64 v[138:139], 0
    v_mov_b64 v[140:141], 0
    v_mov_b64 v[142:143], 0
    v_mov_b64 v[52:53], 0
    v_mov_b64 v[54:55], 0
    v_mov_b64 v[56:57], 0
    v_mov_b64 v[58:59], 0
    v_cndmask_b32 v16, 0, v16, s[28:29]
    v_cndmask_b32 v17, 0, v17, s[28:29]
    v_mov_b32 v147, 0
    v_dot2_f32_bf16 v147, v12, v12, v147
    v_dot2_f32_bf16 v147, v13, v13, v147
    v_dot2_f32_bf16 v147, v14, v14, v147
    v_dot2_f32_bf16 v147, v15, v15, v147
    v_dot2_f32_bf16 v147, v16, v16, v147
    v_dot2_f32_bf16 v147, v17, v17, v147
    s_barrier
    ds_read_b32 v146, v146
    ds_read_b128 v[20:23], v144
    ds_read_b64 v[24:25], v145 offset:1024
    ds_read_b128 v[28:31], v3 offset:12288
    ds_read_b64 v[32:33], v4 offset:12288
    ds_read_b128 v[44:47], v3 offset:15360
    ds_read_b64 v[48:49], v4 offset:15360
    ds_read_b128 v[36:39], v5 offset:12288
    ds_read_b128 v[40:43], v5 offset:13056
    v_mov_b32 v149, v147
    s_waitcnt lgkmcnt(6)
    v_and_b32 v146, 0xffff0000, v146
    v_permlane32_swap_b32 v147, v149
    s_nop 0
    v_max_f32_dpp v146, v146, v146 row_shr:1 row_mask:0xf bank_mask:0xf
    v_add_f32 v147, v147, v149
    s_nop 0
    v_max_f32_dpp v146, v146, v146 row_shr:2 row_mask:0xf bank_mask:0xf
    v_cndmask_b32 v24, 0, v24, s[28:29]
    v_cndmask_b32 v25, 0, v25, s[28:29]
    v_mov_b32 v148, 0
    v_max_f32_dpp v146, v146, v146 row_shr:4 row_mask:0xf bank_mask:0xf
    v_dot2_f32_bf16 v148, v20, v20, v148
    v_dot2_f32_bf16 v148, v21, v21, v148
    v_dot2_f32_bf16 v148, v22, v22, v148
    v_max_f32_dpp v146, v146, v146 row_shr:8 row_mask:0xf bank_mask:0xf
    v_dot2_f32_bf16 v148, v23, v23, v148
    v_dot2_f32_bf16 v148, v24, v24, v148
    v_dot2_f32_bf16 v148, v25, v25, v148
    v_max_f32_dpp v146, v146, v146 row_bcast:15 row_mask:0xa bank_mask:0xf
    s_nop 1
    v_mov_b32 v150, v148
    v_max_f32_dpp v146, v146, v146 row_bcast:31 row_mask:0xc bank_mask:0xf
    s_nop 0
    v_permlane32_swap_b32 v148, v150
    v_readlane_b32 s26, v146, 63
    s_nop 0
    v_add_f32 v148, v148, v150
    v_mul_f32 v147, s26, v147
    v_mul_f32 v148, s26, v148
    v_sqrt_f32 v147, v147
    v_sqrt_f32 v148, v148
    v_mul_f32 v147, 0x3f828f5c, v147
    v_mul_f32 v148, 0x3f828f5c, v148
    v_and_b32 v149, 0xffff0000, v147
    v_sub_f32 v150, v147, v149
    v_lshrrev_b32 v18, 16, v149
    v_and_b32 v149, 0xffff0000, v150
    v_or_b32 v18, v18, v149
    v_sub_f32 v150, v150, v149
    v_lshrrev_b32 v19, 16, v150
    v_xor_b32 v18, 0x80008000, v18
    v_xor_b32 v19, 0x8000, v19
    v_cndmask_b32 v16, v18, v16, s[28:29]
    v_cndmask_b32 v17, v19, v17, s[28:29]
    v_and_b32 v149, 0xffff0000, v148
    v_sub_f32 v150, v148, v149
    v_lshrrev_b32 v26, 16, v149
    v_and_b32 v149, 0xffff0000, v150
    v_or_b32 v26, v26, v149
    v_sub_f32 v150, v150, v149
    v_lshrrev_b32 v27, 16, v150
    v_xor_b32 v26, 0x80008000, v26
    v_xor_b32 v27, 0x8000, v27
    v_cndmask_b32 v24, v26, v24, s[28:29]
    v_cndmask_b32 v25, v27, v25, s[28:29]
    s_waitcnt lgkmcnt(0)
    v_mfma_f32_32x32x16_bf16 v[64:79], v[28:31], v[12:15], 0
    v_mfma_f32_32x32x8_bf16 v[64:79], v[32:33], v[16:17], v[64:79]
    s_nop 11
.p2align 6
gated_mix__grouped_kv_mqa__geglu_ffn__prompt_kernel_aloop:
    v_mfma_f32_32x32x16_bf16 v[80:95], v[28:31], v[20:23], 0
    v_exp_f32 v64, v64
    v_exp_f32 v65, v65
    v_exp_f32 v66, v66
    v_exp_f32 v67, v67
    v_cvt_pk_bf16_f32 v128, v64, v65
    v_mfma_f32_32x32x8_bf16 v[80:95], v[32:33], v[24:25], v[80:95]
    v_exp_f32 v68, v68
    v_exp_f32 v69, v69
    v_cvt_pk_bf16_f32 v129, v66, v67
    v_exp_f32 v70, v70
    v_exp_f32 v71, v71
    v_cvt_pk_bf16_f32 v130, v68, v69
    v_mfma_f32_32x32x16_bf16 v[112:127], v[52:55], v[136:139], v[112:127]
    v_exp_f32 v72, v72
    v_exp_f32 v73, v73
    v_cvt_pk_bf16_f32 v131, v70, v71
    v_exp_f32 v74, v74
    v_exp_f32 v75, v75
    v_cvt_pk_bf16_f32 v132, v72, v73
    v_mfma_f32_32x32x16_bf16 v[112:127], v[56:59], v[140:143], v[112:127]
    v_exp_f32 v76, v76
    v_exp_f32 v77, v77
    v_cvt_pk_bf16_f32 v133, v74, v75
    v_exp_f32 v78, v78
    v_exp_f32 v79, v79
    v_cvt_pk_bf16_f32 v134, v76, v77
    v_cvt_pk_bf16_f32 v135, v78, v79
    s_waitcnt lgkmcnt(0)
    s_barrier
    v_mfma_f32_32x32x16_bf16 v[64:79], v[44:47], v[12:15], 0
    ds_read_b128 v[28:31], v3 offset:18432
    v_exp_f32 v80, v80
    v_exp_f32 v81, v81
    v_exp_f32 v82, v82
    v_exp_f32 v83, v83
    v_cvt_pk_bf16_f32 v136, v80, v81
    v_mfma_f32_32x32x8_bf16 v[64:79], v[48:49], v[16:17], v[64:79]
    ds_read_b64 v[32:33], v4 offset:18432
    v_exp_f32 v84, v84
    v_exp_f32 v85, v85
    v_cvt_pk_bf16_f32 v137, v82, v83
    v_exp_f32 v86, v86
    v_exp_f32 v87, v87
    v_cvt_pk_bf16_f32 v138, v84, v85
    v_mfma_f32_32x32x16_bf16 v[96:111], v[36:39], v[128:131], v[96:111]
    ds_read_b128 v[52:55], v5 offset:15360
    v_exp_f32 v88, v88
    v_exp_f32 v89, v89
    v_cvt_pk_bf16_f32 v139, v86, v87
    v_exp_f32 v90, v90
    v_exp_f32 v91, v91
    v_cvt_pk_bf16_f32 v140, v88, v89
    v_mfma_f32_32x32x16_bf16 v[96:111], v[40:43], v[132:135], v[96:111]
    ds_read_b128 v[56:59], v5 offset:16128
    v_exp_f32 v92, v92
    v_exp_f32 v93, v93
    v_cvt_pk_bf16_f32 v141, v90, v91
    v_exp_f32 v94, v94
    v_exp_f32 v95, v95
    v_cvt_pk_bf16_f32 v142, v92, v93
    v_cvt_pk_bf16_f32 v143, v94, v95
    v_mfma_f32_32x32x16_bf16 v[80:95], v[44:47], v[20:23], 0
    v_exp_f32 v64, v64
    v_exp_f32 v65, v65
    v_exp_f32 v66, v66
    v_exp_f32 v67, v67
    v_cvt_pk_bf16_f32 v128, v64, v65
    v_mfma_f32_32x32x8_bf16 v[80:95], v[48:49], v[24:25], v[80:95]
    v_exp_f32 v68, v68
    v_exp_f32 v69, v69
    v_cvt_pk_bf16_f32 v129, v66, v67
    v_exp_f32 v70, v70
    v_exp_f32 v71, v71
    v_cvt_pk_bf16_f32 v130, v68, v69
    v_mfma_f32_32x32x16_bf16 v[112:127], v[36:39], v[136:139], v[112:127]
    v_exp_f32 v72, v72
    v_exp_f32 v73, v73
    v_cvt_pk_bf16_f32 v131, v70, v71
    v_exp_f32 v74, v74
    v_exp_f32 v75, v75
    v_cvt_pk_bf16_f32 v132, v72, v73
    v_mfma_f32_32x32x16_bf16 v[112:127], v[40:43], v[140:143], v[112:127]
    v_exp_f32 v76, v76
    v_exp_f32 v77, v77
    v_cvt_pk_bf16_f32 v133, v74, v75
    v_exp_f32 v78, v78
    v_exp_f32 v79, v79
    v_cvt_pk_bf16_f32 v134, v76, v77
    v_cvt_pk_bf16_f32 v135, v78, v79
    s_waitcnt lgkmcnt(0)
    v_mfma_f32_32x32x16_bf16 v[64:79], v[28:31], v[12:15], 0
    ds_read_b128 v[44:47], v3 offset:21504
    v_exp_f32 v80, v80
    v_exp_f32 v81, v81
    v_exp_f32 v82, v82
    v_exp_f32 v83, v83
    v_cvt_pk_bf16_f32 v136, v80, v81
    v_mfma_f32_32x32x8_bf16 v[64:79], v[32:33], v[16:17], v[64:79]
    ds_read_b64 v[48:49], v4 offset:21504
    v_exp_f32 v84, v84
    v_exp_f32 v85, v85
    v_cvt_pk_bf16_f32 v137, v82, v83
    v_exp_f32 v86, v86
    v_exp_f32 v87, v87
    v_cvt_pk_bf16_f32 v138, v84, v85
    v_mfma_f32_32x32x16_bf16 v[96:111], v[52:55], v[128:131], v[96:111]
    ds_read_b128 v[36:39], v5 offset:18432
    v_exp_f32 v88, v88
    v_exp_f32 v89, v89
    v_cvt_pk_bf16_f32 v139, v86, v87
    v_exp_f32 v90, v90
    v_exp_f32 v91, v91
    v_cvt_pk_bf16_f32 v140, v88, v89
    v_mfma_f32_32x32x16_bf16 v[96:111], v[56:59], v[132:135], v[96:111]
    ds_read_b128 v[40:43], v5 offset:19200
    v_exp_f32 v92, v92
    v_exp_f32 v93, v93
    v_cvt_pk_bf16_f32 v141, v90, v91
    v_exp_f32 v94, v94
    v_exp_f32 v95, v95
    v_cvt_pk_bf16_f32 v142, v92, v93
    v_cvt_pk_bf16_f32 v143, v94, v95
    v_mfma_f32_32x32x16_bf16 v[80:95], v[28:31], v[20:23], 0
    v_exp_f32 v64, v64
    v_exp_f32 v65, v65
    v_exp_f32 v66, v66
    v_exp_f32 v67, v67
    v_cvt_pk_bf16_f32 v128, v64, v65
    v_mfma_f32_32x32x8_bf16 v[80:95], v[32:33], v[24:25], v[80:95]
    v_exp_f32 v68, v68
    v_exp_f32 v69, v69
    v_cvt_pk_bf16_f32 v129, v66, v67
    v_exp_f32 v70, v70
    v_exp_f32 v71, v71
    v_cvt_pk_bf16_f32 v130, v68, v69
    v_mfma_f32_32x32x16_bf16 v[112:127], v[52:55], v[136:139], v[112:127]
    v_exp_f32 v72, v72
    v_exp_f32 v73, v73
    v_cvt_pk_bf16_f32 v131, v70, v71
    v_exp_f32 v74, v74
    v_exp_f32 v75, v75
    v_cvt_pk_bf16_f32 v132, v72, v73
    v_mfma_f32_32x32x16_bf16 v[112:127], v[56:59], v[140:143], v[112:127]
    v_exp_f32 v76, v76
    v_exp_f32 v77, v77
    v_cvt_pk_bf16_f32 v133, v74, v75
    v_exp_f32 v78, v78
    v_exp_f32 v79, v79
    v_cvt_pk_bf16_f32 v134, v76, v77
    v_cvt_pk_bf16_f32 v135, v78, v79
    s_waitcnt lgkmcnt(0)
    v_mfma_f32_32x32x16_bf16 v[64:79], v[44:47], v[12:15], 0
    ds_read_b128 v[28:31], v3 offset:24576
    v_exp_f32 v80, v80
    v_exp_f32 v81, v81
    v_exp_f32 v82, v82
    v_exp_f32 v83, v83
    v_cvt_pk_bf16_f32 v136, v80, v81
    v_mfma_f32_32x32x8_bf16 v[64:79], v[48:49], v[16:17], v[64:79]
    ds_read_b64 v[32:33], v4 offset:24576
    v_exp_f32 v84, v84
    v_exp_f32 v85, v85
    v_cvt_pk_bf16_f32 v137, v82, v83
    v_exp_f32 v86, v86
    v_exp_f32 v87, v87
    v_cvt_pk_bf16_f32 v138, v84, v85
    v_mfma_f32_32x32x16_bf16 v[96:111], v[36:39], v[128:131], v[96:111]
    ds_read_b128 v[52:55], v5 offset:21504
    v_exp_f32 v88, v88
    v_exp_f32 v89, v89
    v_cvt_pk_bf16_f32 v139, v86, v87
    v_exp_f32 v90, v90
    v_exp_f32 v91, v91
    v_cvt_pk_bf16_f32 v140, v88, v89
    v_mfma_f32_32x32x16_bf16 v[96:111], v[40:43], v[132:135], v[96:111]
    ds_read_b128 v[56:59], v5 offset:22272
    v_exp_f32 v92, v92
    v_exp_f32 v93, v93
    v_cvt_pk_bf16_f32 v141, v90, v91
    v_exp_f32 v94, v94
    v_exp_f32 v95, v95
    v_cvt_pk_bf16_f32 v142, v92, v93
    v_cvt_pk_bf16_f32 v143, v94, v95
    v_mfma_f32_32x32x16_bf16 v[80:95], v[44:47], v[20:23], 0
    v_exp_f32 v64, v64
    v_exp_f32 v65, v65
    v_exp_f32 v66, v66
    v_exp_f32 v67, v67
    v_cvt_pk_bf16_f32 v128, v64, v65
    v_mfma_f32_32x32x8_bf16 v[80:95], v[48:49], v[24:25], v[80:95]
    v_exp_f32 v68, v68
    v_exp_f32 v69, v69
    v_cvt_pk_bf16_f32 v129, v66, v67
    v_exp_f32 v70, v70
    v_exp_f32 v71, v71
    v_cvt_pk_bf16_f32 v130, v68, v69
    v_mfma_f32_32x32x16_bf16 v[112:127], v[36:39], v[136:139], v[112:127]
    v_exp_f32 v72, v72
    v_exp_f32 v73, v73
    v_cvt_pk_bf16_f32 v131, v70, v71
    v_exp_f32 v74, v74
    v_exp_f32 v75, v75
    v_cvt_pk_bf16_f32 v132, v72, v73
    v_mfma_f32_32x32x16_bf16 v[112:127], v[40:43], v[140:143], v[112:127]
    v_exp_f32 v76, v76
    v_exp_f32 v77, v77
    v_cvt_pk_bf16_f32 v133, v74, v75
    v_exp_f32 v78, v78
    v_exp_f32 v79, v79
    v_cvt_pk_bf16_f32 v134, v76, v77
    v_cvt_pk_bf16_f32 v135, v78, v79
    s_waitcnt vmcnt(0) lgkmcnt(0)
    v_mfma_f32_32x32x16_bf16 v[64:79], v[28:31], v[12:15], 0
    ds_read_b128 v[44:47], v3 offset:27648
    v_exp_f32 v80, v80
    v_exp_f32 v81, v81
    v_exp_f32 v82, v82
    v_exp_f32 v83, v83
    v_cvt_pk_bf16_f32 v136, v80, v81
    v_mfma_f32_32x32x8_bf16 v[64:79], v[32:33], v[16:17], v[64:79]
    ds_read_b64 v[48:49], v4 offset:27648
    v_exp_f32 v84, v84
    v_exp_f32 v85, v85
    v_cvt_pk_bf16_f32 v137, v82, v83
    v_exp_f32 v86, v86
    v_exp_f32 v87, v87
    v_cvt_pk_bf16_f32 v138, v84, v85
    v_mfma_f32_32x32x16_bf16 v[96:111], v[52:55], v[128:131], v[96:111]
    ds_read_b128 v[36:39], v5 offset:24576
    v_exp_f32 v88, v88
    v_exp_f32 v89, v89
    v_cvt_pk_bf16_f32 v139, v86, v87
    v_exp_f32 v90, v90
    v_exp_f32 v91, v91
    v_cvt_pk_bf16_f32 v140, v88, v89
    v_mfma_f32_32x32x16_bf16 v[96:111], v[56:59], v[132:135], v[96:111]
    ds_read_b128 v[40:43], v5 offset:25344
    s_cmp_eq_u32 s30, 5
    v_exp_f32 v92, v92
    v_exp_f32 v93, v93
    v_cvt_pk_bf16_f32 v141, v90, v91
    v_exp_f32 v94, v94
    v_exp_f32 v95, v95
    v_cvt_pk_bf16_f32 v142, v92, v93
    v_cvt_pk_bf16_f32 v143, v94, v95
    s_cbranch_scc1 gated_mix__grouped_kv_mqa__geglu_ffn__prompt_kernel_adone
    v_mfma_f32_32x32x16_bf16 v[80:95], v[28:31], v[20:23], 0
    v_exp_f32 v64, v64
    v_exp_f32 v65, v65
    v_exp_f32 v66, v66
    v_exp_f32 v67, v67
    v_cvt_pk_bf16_f32 v128, v64, v65
    v_mfma_f32_32x32x8_bf16 v[80:95], v[32:33], v[24:25], v[80:95]
    v_exp_f32 v68, v68
    v_exp_f32 v69, v69
    v_cvt_pk_bf16_f32 v129, v66, v67
    v_exp_f32 v70, v70
    v_exp_f32 v71, v71
    v_cvt_pk_bf16_f32 v130, v68, v69
    v_mfma_f32_32x32x16_bf16 v[112:127], v[52:55], v[136:139], v[112:127]
    v_exp_f32 v72, v72
    v_exp_f32 v73, v73
    v_cvt_pk_bf16_f32 v131, v70, v71
    v_exp_f32 v74, v74
    v_exp_f32 v75, v75
    v_cvt_pk_bf16_f32 v132, v72, v73
    v_mfma_f32_32x32x16_bf16 v[112:127], v[56:59], v[140:143], v[112:127]
    v_exp_f32 v76, v76
    v_exp_f32 v77, v77
    v_cvt_pk_bf16_f32 v133, v74, v75
    v_exp_f32 v78, v78
    v_exp_f32 v79, v79
    v_cvt_pk_bf16_f32 v134, v76, v77
    v_cvt_pk_bf16_f32 v135, v78, v79
    s_waitcnt lgkmcnt(0)
    s_barrier
    v_mfma_f32_32x32x16_bf16 v[64:79], v[44:47], v[12:15], 0
    ds_read_b128 v[28:31], v3 offset:30720
    v_exp_f32 v80, v80
    v_exp_f32 v81, v81
    v_exp_f32 v82, v82
    v_exp_f32 v83, v83
    v_cvt_pk_bf16_f32 v136, v80, v81
    v_mfma_f32_32x32x8_bf16 v[64:79], v[48:49], v[16:17], v[64:79]
    ds_read_b64 v[32:33], v4 offset:30720
    v_exp_f32 v84, v84
    v_exp_f32 v85, v85
    v_cvt_pk_bf16_f32 v137, v82, v83
    v_exp_f32 v86, v86
    v_exp_f32 v87, v87
    v_cvt_pk_bf16_f32 v138, v84, v85
    v_mfma_f32_32x32x16_bf16 v[96:111], v[36:39], v[128:131], v[96:111]
    ds_read_b128 v[52:55], v5 offset:27648
    v_exp_f32 v88, v88
    v_exp_f32 v89, v89
    v_cvt_pk_bf16_f32 v139, v86, v87
    v_exp_f32 v90, v90
    v_exp_f32 v91, v91
    v_cvt_pk_bf16_f32 v140, v88, v89
    v_mfma_f32_32x32x16_bf16 v[96:111], v[40:43], v[132:135], v[96:111]
    ds_read_b128 v[56:59], v5 offset:28416
    v_exp_f32 v92, v92
    v_exp_f32 v93, v93
    v_cvt_pk_bf16_f32 v141, v90, v91
    v_exp_f32 v94, v94
    v_exp_f32 v95, v95
    v_cvt_pk_bf16_f32 v142, v92, v93
    v_cvt_pk_bf16_f32 v143, v94, v95
    v_mfma_f32_32x32x16_bf16 v[80:95], v[44:47], v[20:23], 0
    v_exp_f32 v64, v64
    v_exp_f32 v65, v65
    v_exp_f32 v66, v66
    v_exp_f32 v67, v67
    v_cvt_pk_bf16_f32 v128, v64, v65
    v_mfma_f32_32x32x8_bf16 v[80:95], v[48:49], v[24:25], v[80:95]
    v_exp_f32 v68, v68
    v_exp_f32 v69, v69
    v_cvt_pk_bf16_f32 v129, v66, v67
    v_exp_f32 v70, v70
    v_exp_f32 v71, v71
    v_cvt_pk_bf16_f32 v130, v68, v69
    v_mfma_f32_32x32x16_bf16 v[112:127], v[36:39], v[136:139], v[112:127]
    v_exp_f32 v72, v72
    v_exp_f32 v73, v73
    v_cvt_pk_bf16_f32 v131, v70, v71
    v_exp_f32 v74, v74
    v_exp_f32 v75, v75
    v_cvt_pk_bf16_f32 v132, v72, v73
    v_mfma_f32_32x32x16_bf16 v[112:127], v[40:43], v[140:143], v[112:127]
    v_exp_f32 v76, v76
    v_exp_f32 v77, v77
    v_cvt_pk_bf16_f32 v133, v74, v75
    v_exp_f32 v78, v78
    v_exp_f32 v79, v79
    v_cvt_pk_bf16_f32 v134, v76, v77
    v_cvt_pk_bf16_f32 v135, v78, v79
    s_waitcnt lgkmcnt(0)
    v_mfma_f32_32x32x16_bf16 v[64:79], v[28:31], v[12:15], 0
    ds_read_b128 v[44:47], v3 offset:33792
    v_exp_f32 v80, v80
    v_exp_f32 v81, v81
    v_exp_f32 v82, v82
    v_exp_f32 v83, v83
    v_cvt_pk_bf16_f32 v136, v80, v81
    v_mfma_f32_32x32x8_bf16 v[64:79], v[32:33], v[16:17], v[64:79]
    ds_read_b64 v[48:49], v4 offset:33792
    v_exp_f32 v84, v84
    v_exp_f32 v85, v85
    v_cvt_pk_bf16_f32 v137, v82, v83
    v_exp_f32 v86, v86
    v_exp_f32 v87, v87
    v_cvt_pk_bf16_f32 v138, v84, v85
    v_mfma_f32_32x32x16_bf16 v[96:111], v[52:55], v[128:131], v[96:111]
    ds_read_b128 v[36:39], v5 offset:30720
    v_exp_f32 v88, v88
    v_exp_f32 v89, v89
    v_cvt_pk_bf16_f32 v139, v86, v87
    v_exp_f32 v90, v90
    v_exp_f32 v91, v91
    v_cvt_pk_bf16_f32 v140, v88, v89
    v_mfma_f32_32x32x16_bf16 v[96:111], v[56:59], v[132:135], v[96:111]
    ds_read_b128 v[40:43], v5 offset:31488
    v_exp_f32 v92, v92
    v_exp_f32 v93, v93
    v_cvt_pk_bf16_f32 v141, v90, v91
    v_exp_f32 v94, v94
    v_exp_f32 v95, v95
    v_cvt_pk_bf16_f32 v142, v92, v93
    v_cvt_pk_bf16_f32 v143, v94, v95
    v_mfma_f32_32x32x16_bf16 v[80:95], v[28:31], v[20:23], 0
    v_exp_f32 v64, v64
    v_exp_f32 v65, v65
    v_exp_f32 v66, v66
    v_exp_f32 v67, v67
    v_cvt_pk_bf16_f32 v128, v64, v65
    v_mfma_f32_32x32x8_bf16 v[80:95], v[32:33], v[24:25], v[80:95]
    v_exp_f32 v68, v68
    v_exp_f32 v69, v69
    v_cvt_pk_bf16_f32 v129, v66, v67
    v_exp_f32 v70, v70
    v_exp_f32 v71, v71
    v_cvt_pk_bf16_f32 v130, v68, v69
    v_mfma_f32_32x32x16_bf16 v[112:127], v[52:55], v[136:139], v[112:127]
    v_exp_f32 v72, v72
    v_exp_f32 v73, v73
    v_cvt_pk_bf16_f32 v131, v70, v71
    v_exp_f32 v74, v74
    v_exp_f32 v75, v75
    v_cvt_pk_bf16_f32 v132, v72, v73
    v_mfma_f32_32x32x16_bf16 v[112:127], v[56:59], v[140:143], v[112:127]
    v_exp_f32 v76, v76
    v_exp_f32 v77, v77
    v_cvt_pk_bf16_f32 v133, v74, v75
    v_exp_f32 v78, v78
    v_exp_f32 v79, v79
    v_cvt_pk_bf16_f32 v134, v76, v77
    v_cvt_pk_bf16_f32 v135, v78, v79
    s_waitcnt lgkmcnt(0)
    v_mfma_f32_32x32x16_bf16 v[64:79], v[44:47], v[12:15], 0
    ds_read_b128 v[28:31], v3 offset:0
    v_exp_f32 v80, v80
    v_exp_f32 v81, v81
    v_exp_f32 v82, v82
    v_exp_f32 v83, v83
    v_cvt_pk_bf16_f32 v136, v80, v81
    v_mfma_f32_32x32x8_bf16 v[64:79], v[48:49], v[16:17], v[64:79]
    ds_read_b64 v[32:33], v4 offset:0
    v_exp_f32 v84, v84
    v_exp_f32 v85, v85
    v_cvt_pk_bf16_f32 v137, v82, v83
    v_exp_f32 v86, v86
    v_exp_f32 v87, v87
    v_cvt_pk_bf16_f32 v138, v84, v85
    v_mfma_f32_32x32x16_bf16 v[96:111], v[36:39], v[128:131], v[96:111]
    ds_read_b128 v[52:55], v5 offset:33792
    v_exp_f32 v88, v88
    v_exp_f32 v89, v89
    v_cvt_pk_bf16_f32 v139, v86, v87
    v_exp_f32 v90, v90
    v_exp_f32 v91, v91
    v_cvt_pk_bf16_f32 v140, v88, v89
    v_mfma_f32_32x32x16_bf16 v[96:111], v[40:43], v[132:135], v[96:111]
    ds_read_b128 v[56:59], v5 offset:34560
    v_exp_f32 v92, v92
    v_exp_f32 v93, v93
    v_cvt_pk_bf16_f32 v141, v90, v91
    v_exp_f32 v94, v94
    v_exp_f32 v95, v95
    v_cvt_pk_bf16_f32 v142, v92, v93
    v_cvt_pk_bf16_f32 v143, v94, v95
    v_mfma_f32_32x32x16_bf16 v[80:95], v[44:47], v[20:23], 0
    v_exp_f32 v64, v64
    v_exp_f32 v65, v65
    v_exp_f32 v66, v66
    v_exp_f32 v67, v67
    v_cvt_pk_bf16_f32 v128, v64, v65
    v_mfma_f32_32x32x8_bf16 v[80:95], v[48:49], v[24:25], v[80:95]
    v_exp_f32 v68, v68
    v_exp_f32 v69, v69
    v_cvt_pk_bf16_f32 v129, v66, v67
    v_exp_f32 v70, v70
    v_exp_f32 v71, v71
    v_cvt_pk_bf16_f32 v130, v68, v69
    v_mfma_f32_32x32x16_bf16 v[112:127], v[36:39], v[136:139], v[112:127]
    v_exp_f32 v72, v72
    v_exp_f32 v73, v73
    v_cvt_pk_bf16_f32 v131, v70, v71
    v_exp_f32 v74, v74
    v_exp_f32 v75, v75
    v_cvt_pk_bf16_f32 v132, v72, v73
    v_mfma_f32_32x32x16_bf16 v[112:127], v[40:43], v[140:143], v[112:127]
    v_exp_f32 v76, v76
    v_exp_f32 v77, v77
    v_cvt_pk_bf16_f32 v133, v74, v75
    v_exp_f32 v78, v78
    v_exp_f32 v79, v79
    v_cvt_pk_bf16_f32 v134, v76, v77
    v_cvt_pk_bf16_f32 v135, v78, v79
    s_waitcnt lgkmcnt(0)
    v_mfma_f32_32x32x16_bf16 v[64:79], v[28:31], v[12:15], 0
    ds_read_b128 v[44:47], v3 offset:3072
    v_exp_f32 v80, v80
    v_exp_f32 v81, v81
    v_exp_f32 v82, v82
    v_exp_f32 v83, v83
    v_cvt_pk_bf16_f32 v136, v80, v81
    v_mfma_f32_32x32x8_bf16 v[64:79], v[32:33], v[16:17], v[64:79]
    ds_read_b64 v[48:49], v4 offset:3072
    v_exp_f32 v84, v84
    v_exp_f32 v85, v85
    v_cvt_pk_bf16_f32 v137, v82, v83
    v_exp_f32 v86, v86
    v_exp_f32 v87, v87
    v_cvt_pk_bf16_f32 v138, v84, v85
    v_mfma_f32_32x32x16_bf16 v[96:111], v[52:55], v[128:131], v[96:111]
    ds_read_b128 v[36:39], v5 offset:0
    v_exp_f32 v88, v88
    v_exp_f32 v89, v89
    v_cvt_pk_bf16_f32 v139, v86, v87
    v_exp_f32 v90, v90
    v_exp_f32 v91, v91
    v_cvt_pk_bf16_f32 v140, v88, v89
    v_mfma_f32_32x32x16_bf16 v[96:111], v[56:59], v[132:135], v[96:111]
    ds_read_b128 v[40:43], v5 offset:768
    v_exp_f32 v92, v92
    v_exp_f32 v93, v93
    v_cvt_pk_bf16_f32 v141, v90, v91
    v_exp_f32 v94, v94
    v_exp_f32 v95, v95
    v_cvt_pk_bf16_f32 v142, v92, v93
    v_cvt_pk_bf16_f32 v143, v94, v95
    v_mfma_f32_32x32x16_bf16 v[80:95], v[28:31], v[20:23], 0
    v_exp_f32 v64, v64
    v_exp_f32 v65, v65
    v_exp_f32 v66, v66
    v_exp_f32 v67, v67
    v_cvt_pk_bf16_f32 v128, v64, v65
    v_mfma_f32_32x32x8_bf16 v[80:95], v[32:33], v[24:25], v[80:95]
    v_exp_f32 v68, v68
    v_exp_f32 v69, v69
    v_cvt_pk_bf16_f32 v129, v66, v67
    v_exp_f32 v70, v70
    v_exp_f32 v71, v71
    v_cvt_pk_bf16_f32 v130, v68, v69
    v_mfma_f32_32x32x16_bf16 v[112:127], v[52:55], v[136:139], v[112:127]
    v_exp_f32 v72, v72
    v_exp_f32 v73, v73
    v_cvt_pk_bf16_f32 v131, v70, v71
    v_exp_f32 v74, v74
    v_exp_f32 v75, v75
    v_cvt_pk_bf16_f32 v132, v72, v73
    v_mfma_f32_32x32x16_bf16 v[112:127], v[56:59], v[140:143], v[112:127]
    v_exp_f32 v76, v76
    v_exp_f32 v77, v77
    v_cvt_pk_bf16_f32 v133, v74, v75
    v_exp_f32 v78, v78
    v_exp_f32 v79, v79
    v_cvt_pk_bf16_f32 v134, v76, v77
    v_cvt_pk_bf16_f32 v135, v78, v79
    s_waitcnt lgkmcnt(0)
    s_barrier
    v_mfma_f32_32x32x16_bf16 v[64:79], v[44:47], v[12:15], 0
    ds_read_b128 v[28:31], v3 offset:6144
    v_exp_f32 v80, v80
    v_exp_f32 v81, v81
    v_exp_f32 v82, v82
    v_exp_f32 v83, v83
    v_cvt_pk_bf16_f32 v136, v80, v81
    v_mfma_f32_32x32x8_bf16 v[64:79], v[48:49], v[16:17], v[64:79]
    ds_read_b64 v[32:33], v4 offset:6144
    v_exp_f32 v84, v84
    v_exp_f32 v85, v85
    v_cvt_pk_bf16_f32 v137, v82, v83
    v_exp_f32 v86, v86
    v_exp_f32 v87, v87
    v_cvt_pk_bf16_f32 v138, v84, v85
    v_mfma_f32_32x32x16_bf16 v[96:111], v[36:39], v[128:131], v[96:111]
    ds_read_b128 v[52:55], v5 offset:3072
    v_exp_f32 v88, v88
    v_exp_f32 v89, v89
    v_cvt_pk_bf16_f32 v139, v86, v87
    v_exp_f32 v90, v90
    v_exp_f32 v91, v91
    v_cvt_pk_bf16_f32 v140, v88, v89
    v_mfma_f32_32x32x16_bf16 v[96:111], v[40:43], v[132:135], v[96:111]
    ds_read_b128 v[56:59], v5 offset:3840
    v_exp_f32 v92, v92
    v_exp_f32 v93, v93
    v_cvt_pk_bf16_f32 v141, v90, v91
    v_exp_f32 v94, v94
    v_exp_f32 v95, v95
    v_cvt_pk_bf16_f32 v142, v92, v93
    v_cvt_pk_bf16_f32 v143, v94, v95
    v_mfma_f32_32x32x16_bf16 v[80:95], v[44:47], v[20:23], 0
    v_exp_f32 v64, v64
    v_exp_f32 v65, v65
    v_exp_f32 v66, v66
    v_exp_f32 v67, v67
    v_cvt_pk_bf16_f32 v128, v64, v65
    v_mfma_f32_32x32x8_bf16 v[80:95], v[48:49], v[24:25], v[80:95]
    v_exp_f32 v68, v68
    v_exp_f32 v69, v69
    v_cvt_pk_bf16_f32 v129, v66, v67
    v_exp_f32 v70, v70
    v_exp_f32 v71, v71
    v_cvt_pk_bf16_f32 v130, v68, v69
    v_mfma_f32_32x32x16_bf16 v[112:127], v[36:39], v[136:139], v[112:127]
    v_exp_f32 v72, v72
    v_exp_f32 v73, v73
    v_cvt_pk_bf16_f32 v131, v70, v71
    v_exp_f32 v74, v74
    v_exp_f32 v75, v75
    v_cvt_pk_bf16_f32 v132, v72, v73
    v_mfma_f32_32x32x16_bf16 v[112:127], v[40:43], v[140:143], v[112:127]
    v_exp_f32 v76, v76
    v_exp_f32 v77, v77
    v_cvt_pk_bf16_f32 v133, v74, v75
    v_exp_f32 v78, v78
    v_exp_f32 v79, v79
    v_cvt_pk_bf16_f32 v134, v76, v77
    v_cvt_pk_bf16_f32 v135, v78, v79
    s_waitcnt lgkmcnt(0)
    v_mfma_f32_32x32x16_bf16 v[64:79], v[28:31], v[12:15], 0
    ds_read_b128 v[44:47], v3 offset:9216
    v_exp_f32 v80, v80
    v_exp_f32 v81, v81
    v_exp_f32 v82, v82
    v_exp_f32 v83, v83
    v_cvt_pk_bf16_f32 v136, v80, v81
    v_mfma_f32_32x32x8_bf16 v[64:79], v[32:33], v[16:17], v[64:79]
    ds_read_b64 v[48:49], v4 offset:9216
    v_exp_f32 v84, v84
    v_exp_f32 v85, v85
    v_cvt_pk_bf16_f32 v137, v82, v83
    v_exp_f32 v86, v86
    v_exp_f32 v87, v87
    v_cvt_pk_bf16_f32 v138, v84, v85
    v_mfma_f32_32x32x16_bf16 v[96:111], v[52:55], v[128:131], v[96:111]
    ds_read_b128 v[36:39], v5 offset:6144
    v_exp_f32 v88, v88
    v_exp_f32 v89, v89
    v_cvt_pk_bf16_f32 v139, v86, v87
    v_exp_f32 v90, v90
    v_exp_f32 v91, v91
    v_cvt_pk_bf16_f32 v140, v88, v89
    v_mfma_f32_32x32x16_bf16 v[96:111], v[56:59], v[132:135], v[96:111]
    ds_read_b128 v[40:43], v5 offset:6912
    v_exp_f32 v92, v92
    v_exp_f32 v93, v93
    v_cvt_pk_bf16_f32 v141, v90, v91
    v_exp_f32 v94, v94
    v_exp_f32 v95, v95
    v_cvt_pk_bf16_f32 v142, v92, v93
    v_cvt_pk_bf16_f32 v143, v94, v95
    v_mfma_f32_32x32x16_bf16 v[80:95], v[28:31], v[20:23], 0
    v_exp_f32 v64, v64
    v_exp_f32 v65, v65
    v_exp_f32 v66, v66
    v_exp_f32 v67, v67
    v_cvt_pk_bf16_f32 v128, v64, v65
    v_mfma_f32_32x32x8_bf16 v[80:95], v[32:33], v[24:25], v[80:95]
    v_exp_f32 v68, v68
    v_exp_f32 v69, v69
    v_cvt_pk_bf16_f32 v129, v66, v67
    v_exp_f32 v70, v70
    v_exp_f32 v71, v71
    v_cvt_pk_bf16_f32 v130, v68, v69
    v_mfma_f32_32x32x16_bf16 v[112:127], v[52:55], v[136:139], v[112:127]
    v_exp_f32 v72, v72
    v_exp_f32 v73, v73
    v_cvt_pk_bf16_f32 v131, v70, v71
    v_exp_f32 v74, v74
    v_exp_f32 v75, v75
    v_cvt_pk_bf16_f32 v132, v72, v73
    v_mfma_f32_32x32x16_bf16 v[112:127], v[56:59], v[140:143], v[112:127]
    v_exp_f32 v76, v76
    v_exp_f32 v77, v77
    v_cvt_pk_bf16_f32 v133, v74, v75
    v_exp_f32 v78, v78
    v_exp_f32 v79, v79
    v_cvt_pk_bf16_f32 v134, v76, v77
    v_cvt_pk_bf16_f32 v135, v78, v79
    s_waitcnt lgkmcnt(0)
    v_mfma_f32_32x32x16_bf16 v[64:79], v[44:47], v[12:15], 0
    ds_read_b128 v[28:31], v3 offset:12288
    v_exp_f32 v80, v80
    v_exp_f32 v81, v81
    v_exp_f32 v82, v82
    v_exp_f32 v83, v83
    v_cvt_pk_bf16_f32 v136, v80, v81
    v_mfma_f32_32x32x8_bf16 v[64:79], v[48:49], v[16:17], v[64:79]
    ds_read_b64 v[32:33], v4 offset:12288
    v_exp_f32 v84, v84
    v_exp_f32 v85, v85
    v_cvt_pk_bf16_f32 v137, v82, v83
    v_exp_f32 v86, v86
    v_exp_f32 v87, v87
    v_cvt_pk_bf16_f32 v138, v84, v85
    v_mfma_f32_32x32x16_bf16 v[96:111], v[36:39], v[128:131], v[96:111]
    ds_read_b128 v[52:55], v5 offset:9216
    v_exp_f32 v88, v88
    v_exp_f32 v89, v89
    v_cvt_pk_bf16_f32 v139, v86, v87
    v_exp_f32 v90, v90
    v_exp_f32 v91, v91
    v_cvt_pk_bf16_f32 v140, v88, v89
    v_mfma_f32_32x32x16_bf16 v[96:111], v[40:43], v[132:135], v[96:111]
    ds_read_b128 v[56:59], v5 offset:9984
    v_exp_f32 v92, v92
    v_exp_f32 v93, v93
    v_cvt_pk_bf16_f32 v141, v90, v91
    v_exp_f32 v94, v94
    v_exp_f32 v95, v95
    v_cvt_pk_bf16_f32 v142, v92, v93
    v_cvt_pk_bf16_f32 v143, v94, v95
    v_mfma_f32_32x32x16_bf16 v[80:95], v[44:47], v[20:23], 0
    v_exp_f32 v64, v64
    v_exp_f32 v65, v65
    v_exp_f32 v66, v66
    v_exp_f32 v67, v67
    v_cvt_pk_bf16_f32 v128, v64, v65
    v_mfma_f32_32x32x8_bf16 v[80:95], v[48:49], v[24:25], v[80:95]
    v_exp_f32 v68, v68
    v_exp_f32 v69, v69
    v_cvt_pk_bf16_f32 v129, v66, v67
    v_exp_f32 v70, v70
    v_exp_f32 v71, v71
    v_cvt_pk_bf16_f32 v130, v68, v69
    v_mfma_f32_32x32x16_bf16 v[112:127], v[36:39], v[136:139], v[112:127]
    v_exp_f32 v72, v72
    v_exp_f32 v73, v73
    v_cvt_pk_bf16_f32 v131, v70, v71
    v_exp_f32 v74, v74
    v_exp_f32 v75, v75
    v_cvt_pk_bf16_f32 v132, v72, v73
    v_mfma_f32_32x32x16_bf16 v[112:127], v[40:43], v[140:143], v[112:127]
    v_exp_f32 v76, v76
    v_exp_f32 v77, v77
    v_cvt_pk_bf16_f32 v133, v74, v75
    v_exp_f32 v78, v78
    v_exp_f32 v79, v79
    v_cvt_pk_bf16_f32 v134, v76, v77
    v_cvt_pk_bf16_f32 v135, v78, v79
    s_waitcnt lgkmcnt(0)
    v_mfma_f32_32x32x16_bf16 v[64:79], v[28:31], v[12:15], 0
    ds_read_b128 v[44:47], v3 offset:15360
    v_exp_f32 v80, v80
    v_exp_f32 v81, v81
    v_exp_f32 v82, v82
    v_exp_f32 v83, v83
    v_cvt_pk_bf16_f32 v136, v80, v81
    v_mfma_f32_32x32x8_bf16 v[64:79], v[32:33], v[16:17], v[64:79]
    ds_read_b64 v[48:49], v4 offset:15360
    v_exp_f32 v84, v84
    v_exp_f32 v85, v85
    v_cvt_pk_bf16_f32 v137, v82, v83
    v_exp_f32 v86, v86
    v_exp_f32 v87, v87
    v_cvt_pk_bf16_f32 v138, v84, v85
    v_mfma_f32_32x32x16_bf16 v[96:111], v[52:55], v[128:131], v[96:111]
    ds_read_b128 v[36:39], v5 offset:12288
    v_exp_f32 v88, v88
    v_exp_f32 v89, v89
    v_cvt_pk_bf16_f32 v139, v86, v87
    v_exp_f32 v90, v90
    v_exp_f32 v91, v91
    v_cvt_pk_bf16_f32 v140, v88, v89
    v_mfma_f32_32x32x16_bf16 v[96:111], v[56:59], v[132:135], v[96:111]
    ds_read_b128 v[40:43], v5 offset:13056
    s_add_u32 s30, s30, 1
    v_exp_f32 v92, v92
    v_exp_f32 v93, v93
    v_cvt_pk_bf16_f32 v141, v90, v91
    v_exp_f32 v94, v94
    v_exp_f32 v95, v95
    v_cvt_pk_bf16_f32 v142, v92, v93
    v_cvt_pk_bf16_f32 v143, v94, v95
    s_branch gated_mix__grouped_kv_mqa__geglu_ffn__prompt_kernel_aloop
gated_mix__grouped_kv_mqa__geglu_ffn__prompt_kernel_adone:
    s_nop 1
    v_mfma_f32_32x32x16_bf16 v[112:127], v[52:55], v[136:139], v[112:127]
    v_mfma_f32_32x32x16_bf16 v[112:127], v[56:59], v[140:143], v[112:127]
    s_mov_b32 s34, 0
gated_mix__grouped_kv_mqa__geglu_ffn__prompt_kernel_aepi:
    s_mov_b32 s35, 0x12800000
    s_waitcnt lgkmcnt(0)
    s_nop 11
    v_mov_b32 v144, v104
    v_mov_b32 v145, v104
    v_mov_b32 v146, v120
    v_mov_b32 v147, v120
    s_nop 0
    v_permlane32_swap_b32 v144, v145
    v_permlane32_swap_b32 v146, v147
    s_nop 0
    v_cmp_nle_f32 vcc, s35, v145
    v_cmp_nle_f32 s[36:37], s35, v147
    v_rcp_f32 v145, v145
    v_rcp_f32 v147, v147
    s_or_b64 s[36:37], vcc, s[36:37]
    s_cmp_eq_u32 s34, 0
    s_cselect_b64 s[36:37], s[36:37], 0
    s_cmp_lg_u64 s[36:37], 0
    s_cbranch_scc1 gated_mix__grouped_kv_mqa__geglu_ffn__prompt_kernel_slow
    v_mul_f32 v96, v145, v96
    v_mul_f32 v97, v145, v97
    v_mul_f32 v98, v145, v98
    v_mul_f32 v99, v145, v99
    v_cvt_pk_bf16_f32 v64, v96, v97
    v_cvt_pk_bf16_f32 v65, v98, v99
    buffer_store_dwordx2 v[64:65], v60, s[8:11], s33 offen offset:0 sc1
    v_mul_f32 v100, v145, v100
    v_mul_f32 v101, v145, v101
    v_mul_f32 v102, v145, v102
    v_mul_f32 v103, v145, v103
    v_cvt_pk_bf16_f32 v66, v100, v101
    v_cvt_pk_bf16_f32 v67, v102, v103
    buffer_store_dwordx2 v[66:67], v60, s[8:11], s33 offen offset:512 sc1
    v_mul_f32 v104, v145, v104
    v_mul_f32 v105, v145, v105
    v_mul_f32 v106, v145, v106
    v_mul_f32 v107, v145, v107
    v_cvt_pk_bf16_f32 v68, v104, v105
    v_cvt_pk_bf16_f32 v69, v106, v107
    s_mov_b32 exec_hi, 0
    buffer_store_dwordx2 v[68:69], v60, s[8:11], s33 offen offset:1024 sc1
    s_mov_b64 exec, -1
    v_mul_f32 v112, v147, v112
    v_mul_f32 v113, v147, v113
    v_mul_f32 v114, v147, v114
    v_mul_f32 v115, v147, v115
    v_cvt_pk_bf16_f32 v72, v112, v113
    v_cvt_pk_bf16_f32 v73, v114, v115
    buffer_store_dwordx2 v[72:73], v60, s[8:11], s31 offen offset:0 sc1
    v_mul_f32 v116, v147, v116
    v_mul_f32 v117, v147, v117
    v_mul_f32 v118, v147, v118
    v_mul_f32 v119, v147, v119
    v_cvt_pk_bf16_f32 v74, v116, v117
    v_cvt_pk_bf16_f32 v75, v118, v119
    buffer_store_dwordx2 v[74:75], v60, s[8:11], s31 offen offset:512 sc1
    v_mul_f32 v120, v147, v120
    v_mul_f32 v121, v147, v121
    v_mul_f32 v122, v147, v122
    v_mul_f32 v123, v147, v123
    v_cvt_pk_bf16_f32 v76, v120, v121
    v_cvt_pk_bf16_f32 v77, v122, v123
    s_mov_b32 exec_hi, 0
    buffer_store_dwordx2 v[76:77], v60, s[8:11], s31 offen offset:1024 sc1
    s_mov_b64 exec, -1
    s_setprio 0
    s_lshl_b32 s36, s20, 5
    s_lshl_b32 s37, s22, 2
    s_add_u32 s36, s36, s37
    s_lshr_b32 s37, s21, 3
    s_add_u32 s36, s36, s37
    s_lshl_b32 s36, s36, 7
    s_add_u32 s36, s36, 3506176
    v_mov_b32 v9, 1
    v_mov_b32 v5, 0
    s_waitcnt vmcnt(0)
    s_mov_b64 exec, 1
    buffer_atomic_add v9, v5, s[8:11], s36 offen sc1
    s_mov_b64 exec, -1
    s_branch gated_mix__grouped_kv_mqa__geglu_ffn__prompt_kernel_p3
gated_mix__grouped_kv_mqa__geglu_ffn__prompt_kernel_slow:
    s_mov_b32 s34, 1
    v_cndmask_b32 v16, 0, v16, s[28:29]
    v_cndmask_b32 v17, 0, v17, s[28:29]
    v_cndmask_b32 v24, 0, v24, s[28:29]
    v_cndmask_b32 v25, 0, v25, s[28:29]
    v_mov_b32 v147, 0xff800000
    v_mov_b32 v148, 0xff800000
    s_mov_b32 s36, 3018752
gated_mix__grouped_kv_mqa__geglu_ffn__prompt_kernel_slow1:
    buffer_load_dwordx4 v[28:31], v3, s[8:11], s36 offen sc1
    buffer_load_dwordx2 v[32:33], v4, s[8:11], s36 offen sc1
    s_add_u32 s36, s36, 3072
    s_waitcnt vmcnt(0)
    v_mfma_f32_32x32x16_bf16 v[64:79], v[28:31], v[12:15], 0
    v_mfma_f32_32x32x8_bf16 v[64:79], v[32:33], v[16:17], v[64:79]
    v_mfma_f32_32x32x16_bf16 v[80:95], v[28:31], v[20:23], 0
    v_mfma_f32_32x32x8_bf16 v[80:95], v[32:33], v[24:25], v[80:95]
    s_nop 15
    v_max3_f32 v147, v64, v65, v147
    v_max3_f32 v148, v80, v81, v148
    v_max3_f32 v147, v66, v67, v147
    v_max3_f32 v148, v82, v83, v148
    v_max3_f32 v147, v68, v69, v147
    v_max3_f32 v148, v84, v85, v148
    v_max3_f32 v147, v70, v71, v147
    v_max3_f32 v148, v86, v87, v148
    v_max3_f32 v147, v72, v73, v147
    v_max3_f32 v148, v88, v89, v148
    v_max3_f32 v147, v74, v75, v147
    v_max3_f32 v148, v90, v91, v148
    v_max3_f32 v147, v76, v77, v147
    v_max3_f32 v148, v92, v93, v148
    v_max3_f32 v147, v78, v79, v147
    v_max3_f32 v148, v94, v95, v148
    s_cmp_lt_u32 s36, 3215360
    s_cbranch_scc1 gated_mix__grouped_kv_mqa__geglu_ffn__prompt_kernel_slow1
    v_mov_b32 v149, v147
    v_mov_b32 v150, v148
    s_nop 1
    v_permlane32_swap_b32 v147, v149
    v_permlane32_swap_b32 v148, v150
    s_nop 1
    v_max_f32 v147, v147, v149
    v_max_f32 v148, v148, v150
    v_and_b32 v149, 0xffff0000, v147
    v_sub_f32 v150, v147, v149
    v_lshrrev_b32 v18, 16, v149
    v_and_b32 v149, 0xffff0000, v150
    v_or_b32 v18, v18, v149
    v_sub_f32 v150, v150, v149
    v_lshrrev_b32 v19, 16, v150
    v_xor_b32 v18, 0x80008000, v18
    v_xor_b32 v19, 0x8000, v19
    v_cndmask_b32 v16, v18, v16, s[28:29]
    v_cndmask_b32 v17, v19, v17, s[28:29]
    v_and_b32 v149, 0xffff0000, v148
    v_sub_f32 v150, v148, v149
    v_lshrrev_b32 v26, 16, v149
    v_and_b32 v149, 0xffff0000, v150
    v_or_b32 v26, v26, v149
    v_sub_f32 v150, v150, v149
    v_lshrrev_b32 v27, 16, v150
    v_xor_b32 v26, 0x80008000, v26
    v_xor_b32 v27, 0x8000, v27
    v_cndmask_b32 v24, v26, v24, s[28:29]
    v_cndmask_b32 v25, v27, v25, s[28:29]
    v_mov_b32 v96, 0
    v_mov_b32 v97, 0
    v_mov_b32 v98, 0
    v_mov_b32 v99, 0
    v_mov_b32 v100, 0
    v_mov_b32 v101, 0
    v_mov_b32 v102, 0
    v_mov_b32 v103, 0
    v_mov_b32 v104, 0
    v_mov_b32 v105, 0
    v_mov_b32 v106, 0
    v_mov_b32 v107, 0
    v_mov_b32 v108, 0
    v_mov_b32 v109, 0
    v_mov_b32 v110, 0
    v_mov_b32 v111, 0
    v_mov_b32 v112, 0
    v_mov_b32 v113, 0
    v_mov_b32 v114, 0
    v_mov_b32 v115, 0
    v_mov_b32 v116, 0
    v_mov_b32 v117, 0
    v_mov_b32 v118, 0
    v_mov_b32 v119, 0
    v_mov_b32 v120, 0
    v_mov_b32 v121, 0
    v_mov_b32 v122, 0
    v_mov_b32 v123, 0
    v_mov_b32 v124, 0
    v_mov_b32 v125, 0
    v_mov_b32 v126, 0
    v_mov_b32 v127, 0
    s_mov_b32 s36, 3018752
gated_mix__grouped_kv_mqa__geglu_ffn__prompt_kernel_slow2:
    buffer_load_dwordx4 v[28:31], v3, s[8:11], s36 offen sc1
    buffer_load_dwordx2 v[32:33], v4, s[8:11], s36 offen sc1
    buffer_load_dwordx4 v[36:39], v5, s[8:11], s36 offen sc1
    buffer_load_dwordx4 v[40:43], v5, s[8:11], s36 offen offset:768 sc1
    s_add_u32 s36, s36, 3072
    s_waitcnt vmcnt(0)
    v_mfma_f32_32x32x16_bf16 v[64:79], v[28:31], v[12:15], 0
    v_mfma_f32_32x32x8_bf16 v[64:79], v[32:33], v[16:17], v[64:79]
    v_mfma_f32_32x32x16_bf16 v[80:95], v[28:31], v[20:23], 0
    v_mfma_f32_32x32x8_bf16 v[80:95], v[32:33], v[24:25], v[80:95]
    s_nop 15
    v_exp_f32 v64, v64
    v_exp_f32 v65, v65
    v_exp_f32 v66, v66
    v_exp_f32 v67, v67
    v_cvt_pk_bf16_f32 v128, v64, v65
    v_exp_f32 v68, v68
    v_exp_f32 v69, v69
    v_cvt_pk_bf16_f32 v129, v66, v67
    v_exp_f32 v70, v70
    v_exp_f32 v71, v71
    v_cvt_pk_bf16_f32 v130, v68, v69
    v_exp_f32 v72, v72
    v_exp_f32 v73, v73
    v_cvt_pk_bf16_f32 v131, v70, v71
    v_exp_f32 v74, v74
    v_exp_f32 v75, v75
    v_cvt_pk_bf16_f32 v132, v72, v73
    v_exp_f32 v76, v76
    v_exp_f32 v77, v77
    v_cvt_pk_bf16_f32 v133, v74, v75
    v_exp_f32 v78, v78
    v_exp_f32 v79, v79
    v_cvt_pk_bf16_f32 v134, v76, v77
    v_cvt_pk_bf16_f32 v135, v78, v79
    v_exp_f32 v80, v80
    v_exp_f32 v81, v81
    v_exp_f32 v82, v82
    v_exp_f32 v83, v83
    v_cvt_pk_bf16_f32 v136, v80, v81
    v_exp_f32 v84, v84
    v_exp_f32 v85, v85
    v_cvt_pk_bf16_f32 v137, v82, v83
    v_exp_f32 v86, v86
    v_exp_f32 v87, v87
    v_cvt_pk_bf16_f32 v138, v84, v85
    v_exp_f32 v88, v88
    v_exp_f32 v89, v89
    v_cvt_pk_bf16_f32 v139, v86, v87
    v_exp_f32 v90, v90
    v_exp_f32 v91, v91
    v_cvt_pk_bf16_f32 v140, v88, v89
    v_exp_f32 v92, v92
    v_exp_f32 v93, v93
    v_cvt_pk_bf16_f32 v141, v90, v91
    v_exp_f32 v94, v94
    v_exp_f32 v95, v95
    v_cvt_pk_bf16_f32 v142, v92, v93
    v_cvt_pk_bf16_f32 v143, v94, v95
    s_nop 1
    v_mfma_f32_32x32x16_bf16 v[96:111], v[36:39], v[128:131], v[96:111]
    v_mfma_f32_32x32x16_bf16 v[96:111], v[40:43], v[132:135], v[96:111]
    v_mfma_f32_32x32x16_bf16 v[112:127], v[36:39], v[136:139], v[112:127]
    v_mfma_f32_32x32x16_bf16 v[112:127], v[40:43], v[140:143], v[112:127]
    s_cmp_lt_u32 s36, 3215360
    s_cbranch_scc1 gated_mix__grouped_kv_mqa__geglu_ffn__prompt_kernel_slow2
    s_nop 7
    s_branch gated_mix__grouped_kv_mqa__geglu_ffn__prompt_kernel_aepi
gated_mix__grouped_kv_mqa__geglu_ffn__prompt_kernel_gwave:
    ds_write_b128 v144, v[12:15]
    ds_write_b64 v145, v[16:17] offset:1024
    s_load_dwordx2 s[6:7], s[0:1], 64
    s_and_b32 s16, s22, 3
    s_and_b32 s57, s21, 3
    s_lshl_b32 s57, s57, 3
    s_lshr_b32 s34, s21, 2
    s_add_u32 s57, s57, s34
    s_cmp_ge_u32 s57, 15
    s_cselect_b32 s33, 1, 0
    s_cselect_b32 s34, 15, 0
    s_sub_u32 s34, s57, s34
    s_lshl_b32 s35, s20, 1
    s_add_u32 s33, s33, s35
    s_mul_i32 s35, s34, 13
    s_lshr_b32 s35, s35, 6
    s_mul_i32 s36, s35, 5
    s_sub_u32 s34, s34, s36
    s_waitcnt lgkmcnt(0)
    s_barrier
    s_lshl_b32 s36, s33, 2
    s_add_u32 s36, s36, s16
    s_mul_i32 s36, s36, 108
    s_mul_i32 s37, s35, 36
    s_add_u32 s36, s36, s37
    s_lshl_b32 s36, s36, 10
    s_add_u32 s40, s36, 4194304
    s_mul_i32 s41, s35, 737280
    s_mul_i32 s36, s16, 20480
    s_add_u32 s41, s41, s36
    s_lshl_b32 s36, s34, 8
    s_add_u32 s41, s41, s36
    v_lshrrev_b32 v3, 4, v1
    v_lshlrev_b32 v4, 2, v3
    v_and_b32 v5, 15, v1
    v_xor_b32 v4, v4, v5
    s_movk_i32 s36, 1280
    v_mul_u32_u24 v3, s36, v3
    v_lshl_add_u32 v3, v4, 4, v3
    v_add_u32 v4, 4096, v3
    v_add_u32 v5, 8192, v3
    v_add_u32 v13, 12288, v3
    s_lshl_b32 s42, s16, 12
    s_add_u32 s43, s42, 16384
    s_mov_b32 s45, 0
    s_mov_b32 s30, 0
    s_mov_b32 s46, 0
    s_cmp_lt_u32 s57, 30
    s_cselect_b32 s47, 9, 0
    s_cselect_b32 s50, 33554432, 0
    s_cselect_b32 s54, 2211840, 0
    s_mov_b32 s48, s18
    s_and_b32 s49, s19, 0xffff
    s_mov_b32 s51, 0x20000
    s_mov_b32 s55, 0x20000
    s_mov_b32 m0, s43
    s_mov_b32 s52, s6
    s_and_b32 s53, s7, 0xffff
    buffer_load_dwordx4 v3, s[52:55], s41 offen lds
    buffer_load_dwordx4 v4, s[52:55], s41 offen offset:1024 lds
    buffer_load_dwordx4 v5, s[52:55], s41 offen offset:2048 lds
    buffer_load_dwordx4 v13, s[52:55], s41 offen offset:3072 lds
    s_add_u32 s41, s41, 81920
    s_and_b32 s36, s16, 1
    s_lshr_b32 s37, s16, 1
    s_lshl_b32 s38, s36, 13
    v_add_u32 v6, s38, v2
    v_lshrrev_b32 v8, 5, v1
    v_bfe_u32 v9, v1, 2, 2
    v_lshl_add_u32 v8, v8, 2, v9
    v_lshlrev_b32 v8, 8, v8
    s_lshl_b32 s38, s37, 1
    v_xor_b32 v9, s38, v9
    v_lshl_add_u32 v8, v9, 6, v8
    v_bfe_u32 v9, v1, 4, 1
    v_lshl_add_u32 v8, v9, 5, v8
    v_and_b32 v9, 3, v1
    v_lshl_add_u32 v8, v9, 3, v8
    v_add_u32 v7, 16384, v8
    v_xor_b32 v8, 64, v7
    v_mov_b64 v[64:65], 0
    v_mov_b64 v[66:67], 0
    v_mov_b64 v[68:69], 0
    v_mov_b64 v[70:71], 0
    v_mov_b64 v[72:73], 0
    v_mov_b64 v[74:75], 0
    v_mov_b64 v[76:77], 0
    v_mov_b64 v[78:79], 0
    v_mov_b64 v[80:81], 0
    v_mov_b64 v[82:83], 0
    v_mov_b64 v[84:85], 0
    v_mov_b64 v[86:87], 0
    v_mov_b64 v[88:89], 0
    v_mov_b64 v[90:91], 0
    v_mov_b64 v[92:93], 0
    v_mov_b64 v[94:95], 0
    v_mov_b64 v[96:97], 0
    v_mov_b64 v[98:99], 0
    v_mov_b64 v[100:101], 0
    v_mov_b64 v[102:103], 0
    v_mov_b64 v[104:105], 0
    v_mov_b64 v[106:107], 0
    v_mov_b64 v[108:109], 0
    v_mov_b64 v[110:111], 0
    v_mov_b64 v[112:113], 0
    v_mov_b64 v[114:115], 0
    v_mov_b64 v[116:117], 0
    v_mov_b64 v[118:119], 0
    v_mov_b64 v[120:121], 0
    v_mov_b64 v[122:123], 0
    v_mov_b64 v[124:125], 0
    v_mov_b64 v[126:127], 0
    s_mov_b32 m0, s42
    s_barrier
    s_waitcnt vmcnt(0)
    s_barrier
    s_barrier
    s_barrier
    buffer_load_dwordx4 v2, s[48:51], s40 offen sc1 lds
    buffer_load_dwordx4 v2, s[48:51], s40 offen offset:1024 sc1 lds
    buffer_load_dwordx4 v2, s[48:51], s40 offen offset:2048 sc1 lds
    buffer_load_dwordx4 v2, s[48:51], s40 offen offset:3072 sc1 lds
    s_add_u32 s40, s40, 4096
    s_mov_b32 s44, 32768
    s_branch gated_mix__grouped_kv_mqa__geglu_ffn__prompt_kernel_gin
gated_mix__grouped_kv_mqa__geglu_ffn__prompt_kernel_gloop:
    s_barrier
gated_mix__grouped_kv_mqa__geglu_ffn__prompt_kernel_gin:
    s_add_u32 s46, s46, 1
    s_cmp_ge_u32 s46, s47
    s_cbranch_scc1 gated_mix__grouped_kv_mqa__geglu_ffn__prompt_kernel_gnod
    s_add_u32 m0, s44, s42
    s_nop 0
    buffer_load_dwordx4 v2, s[48:51], s40 offen sc1 lds
    buffer_load_dwordx4 v2, s[48:51], s40 offen offset:1024 sc1 lds
    buffer_load_dwordx4 v2, s[48:51], s40 offen offset:2048 sc1 lds
    buffer_load_dwordx4 v2, s[48:51], s40 offen offset:3072 sc1 lds
    s_add_u32 s40, s40, 4096
    s_add_u32 m0, s44, s43
    s_add_u32 s44, s44, 32768
    buffer_load_dwordx4 v3, s[52:55], s41 offen lds
    buffer_load_dwordx4 v4, s[52:55], s41 offen offset:1024 lds
    buffer_load_dwordx4 v5, s[52:55], s41 offen offset:2048 lds
    buffer_load_dwordx4 v13, s[52:55], s41 offen offset:3072 lds
    s_add_u32 s41, s41, 81920
    s_cmp_ge_u32 s44, 98304
    s_cselect_b32 s44, 0, s44
gated_mix__grouped_kv_mqa__geglu_ffn__prompt_kernel_gnod:
    s_sub_u32 s36, s30, 1
    s_cmp_ge_u32 s36, s47
    s_cbranch_scc1 gated_mix__grouped_kv_mqa__geglu_ffn__prompt_kernel_gskip
    v_add_u32 v10, s45, v6
    v_add_u32 v11, s45, v7
    v_add_u32 v12, s45, v8
    s_add_u32 s45, s45, 32768
    s_cmp_ge_u32 s45, 98304
    s_cselect_b32 s45, 0, s45
    ds_read_b128 v[16:19], v10 offset:0
    ds_read_b64_tr_b16 v[24:25], v11 offset:0
    ds_read_b64_tr_b16 v[26:27], v11 offset:2048
    ds_read_b64_tr_b16 v[28:29], v12 offset:0
    ds_read_b64_tr_b16 v[30:31], v12 offset:2048
    ds_read_b128 v[20:23], v10 offset:4096
    s_waitcnt lgkmcnt(0)
    v_mfma_f32_32x32x16_bf16 v[64:79], v[24:27], v[16:19], v[64:79]
    ds_read_b128 v[32:35], v10 offset:1024
    ds_read_b64_tr_b16 v[40:41], v11 offset:4096
    v_mfma_f32_32x32x16_bf16 v[80:95], v[28:31], v[16:19], v[80:95]
    ds_read_b64_tr_b16 v[42:43], v11 offset:6144
    ds_read_b64_tr_b16 v[44:45], v12 offset:4096
    v_mfma_f32_32x32x16_bf16 v[96:111], v[24:27], v[20:23], v[96:111]
    ds_read_b64_tr_b16 v[46:47], v12 offset:6144
    ds_read_b128 v[36:39], v10 offset:5120
    v_mfma_f32_32x32x16_bf16 v[112:127], v[28:31], v[20:23], v[112:127]
    s_waitcnt lgkmcnt(0)
    v_mfma_f32_32x32x16_bf16 v[64:79], v[40:43], v[32:35], v[64:79]
    ds_read_b128 v[16:19], v10 offset:2048
    ds_read_b64_tr_b16 v[24:25], v11 offset:8192
    v_mfma_f32_32x32x16_bf16 v[80:95], v[44:47], v[32:35], v[80:95]
    ds_read_b64_tr_b16 v[26:27], v11 offset:10240
    ds_read_b64_tr_b16 v[28:29], v12 offset:8192
    v_mfma_f32_32x32x16_bf16 v[96:111], v[40:43], v[36:39], v[96:111]
    ds_read_b64_tr_b16 v[30:31], v12 offset:10240
    ds_read_b128 v[20:23], v10 offset:6144
    v_mfma_f32_32x32x16_bf16 v[112:127], v[44:47], v[36:39], v[112:127]
    s_waitcnt lgkmcnt(0)
    v_mfma_f32_32x32x16_bf16 v[64:79], v[24:27], v[16:19], v[64:79]
    ds_read_b128 v[32:35], v10 offset:3072
    ds_read_b64_tr_b16 v[40:41], v11 offset:12288
    v_mfma_f32_32x32x16_bf16 v[80:95], v[28:31], v[16:19], v[80:95]
    ds_read_b64_tr_b16 v[42:43], v11 offset:14336
    ds_read_b64_tr_b16 v[44:45], v12 offset:12288
    v_mfma_f32_32x32x16_bf16 v[96:111], v[24:27], v[20:23], v[96:111]
    ds_read_b64_tr_b16 v[46:47], v12 offset:14336
    ds_read_b128 v[36:39], v10 offset:7168
    v_mfma_f32_32x32x16_bf16 v[112:127], v[28:31], v[20:23], v[112:127]
    s_waitcnt lgkmcnt(0)
    v_mfma_f32_32x32x16_bf16 v[64:79], v[40:43], v[32:35], v[64:79]
    v_mfma_f32_32x32x16_bf16 v[80:95], v[44:47], v[32:35], v[80:95]
    v_mfma_f32_32x32x16_bf16 v[96:111], v[40:43], v[36:39], v[96:111]
    v_mfma_f32_32x32x16_bf16 v[112:127], v[44:47], v[36:39], v[112:127]
    s_cmp_lg_u32 s30, s47
    s_cbranch_scc1 gated_mix__grouped_kv_mqa__geglu_ffn__prompt_kernel_gskip
    s_lshl_b32 s36, s35, 6
    s_lshl_b32 s37, s33, 2
    s_add_u32 s36, s36, s37
    s_and_b32 s37, s16, 1
    s_lshl_b32 s37, s37, 1
    s_add_u32 s36, s36, s37
    s_mul_i32 s36, s36, 40
    s_lshl_b32 s37, s34, 3
    s_add_u32 s36, s36, s37
    s_lshr_b32 s37, s16, 1
    s_lshl_b32 s37, s37, 2
    s_add_u32 s36, s36, s37
    s_lshl_b32 s36, s36, 10
    s_add_u32 s36, s36, 16777216
    s_add_u32 s37, s36, 40960
    s_nop 7
    v_cvt_pk_bf16_f32 v16, v64, v65
    v_cvt_pk_bf16_f32 v17, v66, v67
    v_cvt_pk_bf16_f32 v18, v68, v69
    v_cvt_pk_bf16_f32 v19, v70, v71
    buffer_store_dwordx4 v[16:19], v2, s[8:11], s36 offen offset:0 sc1
    v_cvt_pk_bf16_f32 v20, v72, v73
    v_cvt_pk_bf16_f32 v21, v74, v75
    v_cvt_pk_bf16_f32 v22, v76, v77
    v_cvt_pk_bf16_f32 v23, v78, v79
    buffer_store_dwordx4 v[20:23], v2, s[8:11], s36 offen offset:1024 sc1
    v_cvt_pk_bf16_f32 v24, v80, v81
    v_cvt_pk_bf16_f32 v25, v82, v83
    v_cvt_pk_bf16_f32 v26, v84, v85
    v_cvt_pk_bf16_f32 v27, v86, v87
    buffer_store_dwordx4 v[24:27], v2, s[8:11], s36 offen offset:2048 sc1
    v_cvt_pk_bf16_f32 v28, v88, v89
    v_cvt_pk_bf16_f32 v29, v90, v91
    v_cvt_pk_bf16_f32 v30, v92, v93
    v_cvt_pk_bf16_f32 v31, v94, v95
    buffer_store_dwordx4 v[28:31], v2, s[8:11], s36 offen offset:3072 sc1
    v_cvt_pk_bf16_f32 v32, v96, v97
    v_cvt_pk_bf16_f32 v33, v98, v99
    v_cvt_pk_bf16_f32 v34, v100, v101
    v_cvt_pk_bf16_f32 v35, v102, v103
    buffer_store_dwordx4 v[32:35], v2, s[8:11], s37 offen offset:0 sc1
    v_cvt_pk_bf16_f32 v36, v104, v105
    v_cvt_pk_bf16_f32 v37, v106, v107
    v_cvt_pk_bf16_f32 v38, v108, v109
    v_cvt_pk_bf16_f32 v39, v110, v111
    buffer_store_dwordx4 v[36:39], v2, s[8:11], s37 offen offset:1024 sc1
    v_cvt_pk_bf16_f32 v40, v112, v113
    v_cvt_pk_bf16_f32 v41, v114, v115
    v_cvt_pk_bf16_f32 v42, v116, v117
    v_cvt_pk_bf16_f32 v43, v118, v119
    buffer_store_dwordx4 v[40:43], v2, s[8:11], s37 offen offset:2048 sc1
    v_cvt_pk_bf16_f32 v44, v120, v121
    v_cvt_pk_bf16_f32 v45, v122, v123
    v_cvt_pk_bf16_f32 v46, v124, v125
    v_cvt_pk_bf16_f32 v47, v126, v127
    buffer_store_dwordx4 v[44:47], v2, s[8:11], s37 offen offset:3072 sc1
    s_branch gated_mix__grouped_kv_mqa__geglu_ffn__prompt_kernel_gend
gated_mix__grouped_kv_mqa__geglu_ffn__prompt_kernel_gskip:
    s_add_u32 s30, s30, 1
    s_cmp_ge_u32 s30, 10
    s_cbranch_scc1 gated_mix__grouped_kv_mqa__geglu_ffn__prompt_kernel_gend
    s_cmp_lt_u32 s46, s47
    s_cbranch_scc1 gated_mix__grouped_kv_mqa__geglu_ffn__prompt_kernel_gw8
    s_waitcnt vmcnt(0)
gated_mix__grouped_kv_mqa__geglu_ffn__prompt_kernel_gw8:
    s_waitcnt vmcnt(8)
    s_branch gated_mix__grouped_kv_mqa__geglu_ffn__prompt_kernel_gloop
gated_mix__grouped_kv_mqa__geglu_ffn__prompt_kernel_gend:
    s_barrier
    s_waitcnt vmcnt(0)
    s_barrier
    s_barrier
gated_mix__grouped_kv_mqa__geglu_ffn__prompt_kernel_p3:
    s_load_dwordx2 s[4:5], s[0:1], 80
    s_lshl_b32 s17, s20, 3
    s_and_b32 s16, s21, 3
    s_lshl_b32 s16, s16, 1
    s_add_u32 s17, s17, s16
    s_lshr_b32 s16, s21, 2
    s_and_b32 s36, s22, 1
    s_lshr_b32 s39, s22, 1
    s_add_u32 s36, s17, s36
    s_mul_i32 s36, s36, 40
    s_mul_i32 s37, s39, 10
    s_add_u32 s36, s36, s37
    s_lshl_b32 s36, s36, 10
    s_add_u32 s36, s36, 12582912
    s_add_u32 s37, s36, 4096
    s_add_u32 s38, s36, 8192
    v_lshrrev_b32 v8, 5, v1
    v_bfe_u32 v9, v1, 2, 2
    v_lshl_add_u32 v8, v8, 2, v9
    v_mul_u32_u24 v8, 192, v8
    v_bfe_u32 v9, v1, 4, 1
    v_lshl_add_u32 v8, v9, 5, v8
    v_and_b32 v9, 3, v1
    v_lshl_add_u32 v8, v9, 3, v8
    s_lshl_b32 s48, s39, 2
    s_mul_i32 s49, s39, 30720
    v_add_u32 v8, s49, v8
    v_lshlrev_b32 v7, 3, v1
    v_and_b32 v6, 31, v1
    s_lshl_b32 s39, s17, 5
    v_add_u32 v6, s39, v6
    v_lshrrev_b32 v4, 3, v6
    v_lshlrev_b32 v4, 7, v4
    v_and_b32 v9, 7, v1
    v_lshl_add_u32 v4, v9, 2, v4
    s_mov_b32 s40, 3670016
    s_mul_i32 s41, s16, 10
    s_add_u32 s41, s41, s22
    s_lshr_b32 s42, s41, 1
    s_lshl_b32 s42, s42, 10
    s_and_b32 s43, s41, 1
    s_lshl_b32 s43, s43, 3
    s_add_u32 s42, s42, s43
    s_mul_i32 s43, s17, 40960
    s_add_u32 s42, s42, s43
    s_add_u32 s42, s42, 16777216
    v_mov_b32 v22, 122880
    s_lshr_b32 s46, s22, 1
    s_lshl_b32 s45, 1, s46
    s_movk_i32 s43, 1280
    v_mul_lo_u32 v6, v6, s43
    v_lshrrev_b32 v9, 5, v1
    v_lshl_add_u32 v6, v9, 3, v6
    s_lshl_b32 s41, s41, 4
    s_add_u32 s44, s41, 40960
    s_waitcnt lgkmcnt(0)
    s_mov_b32 s12, s4
    s_and_b32 s13, s5, 0xffff
    s_mov_b32 s14, 2621440
    s_mov_b32 s15, 0x20000
    v_mov_b64 v[64:65], 0
    v_mov_b64 v[66:67], 0
    v_mov_b64 v[68:69], 0
    v_mov_b64 v[70:71], 0
    v_mov_b64 v[72:73], 0
    v_mov_b64 v[74:75], 0
    v_mov_b64 v[76:77], 0
    v_mov_b64 v[78:79], 0
    v_mov_b64 v[80:81], 0
    v_mov_b64 v[82:83], 0
    v_mov_b64 v[84:85], 0
    v_mov_b64 v[86:87], 0
    v_mov_b64 v[88:89], 0
    v_mov_b64 v[90:91], 0
    v_mov_b64 v[92:93], 0
    v_mov_b64 v[94:95], 0
    v_mov_b64 v[96:97], 0
    v_mov_b64 v[98:99], 0
    v_mov_b64 v[100:101], 0
    v_mov_b64 v[102:103], 0
    v_mov_b64 v[104:105], 0
    v_mov_b64 v[106:107], 0
    v_mov_b64 v[108:109], 0
    v_mov_b64 v[110:111], 0
    s_mov_b32 s70, 65536
    s_cmp_lg_u32 s22, 8
    s_cbranch_scc1 gated_mix__grouped_kv_mqa__geglu_ffn__prompt_kernel_p3w1
    s_mov_b64 exec, 0xf
gated_mix__grouped_kv_mqa__geglu_ffn__prompt_kernel_p3poll:
    buffer_load_dword v24, v3, s[8:11], s35 offen sc1
    s_sub_u32 s70, s70, 1
    s_cselect_b32 s47, -1, 0
    s_waitcnt vmcnt(0)
    v_cmp_eq_u32 vcc, 8, v24
    s_or_b32 s47, s47, vcc_lo
    s_or_b32 s47, s47, 0xfffffff0
    v_mov_b32 v23, s47
    ds_write_b32 v22, v23 offset:8
    s_sleep 2
    s_cmp_lg_u32 s47, -1
    s_cbranch_scc1 gated_mix__grouped_kv_mqa__geglu_ffn__prompt_kernel_p3poll
    s_mov_b64 exec, -1
gated_mix__grouped_kv_mqa__geglu_ffn__prompt_kernel_p3w1:
    ds_read_b32 v10, v22 offset:12
    s_waitcnt lgkmcnt(0)
    v_readfirstlane_b32 s46, v10
    s_cmp_eq_u32 s46, 2
    s_cbranch_scc1 gated_mix__grouped_kv_mqa__geglu_ffn__prompt_kernel_p3rdy
    s_sleep 1
    s_branch gated_mix__grouped_kv_mqa__geglu_ffn__prompt_kernel_p3w1
gated_mix__grouped_kv_mqa__geglu_ffn__prompt_kernel_p3rdy:
    buffer_load_dword v140, v4, s[8:11], s40 offen sc1
    buffer_load_dword v141, v4, s[8:11], s40 offen offset:512 sc1
    s_add_u32 s43, s42, 0
    buffer_load_dwordx2 v[128:129], v2, s[8:11], s43 offen sc1
    s_add_u32 s43, s42, 2621440
    buffer_load_dwordx2 v[130:131], v2, s[8:11], s43 offen sc1
    s_add_u32 s43, s42, 5242880
    buffer_load_dwordx2 v[132:133], v2, s[8:11], s43 offen sc1
    s_add_u32 s43, s42, 40960
    buffer_load_dwordx2 v[134:135], v2, s[8:11], s43 offen sc1
    s_add_u32 s43, s42, 2662400
    buffer_load_dwordx2 v[136:137], v2, s[8:11], s43 offen sc1
    s_add_u32 s43, s42, 5283840
    buffer_load_dwordx2 v[138:139], v2, s[8:11], s43 offen sc1
    ds_read_b64_tr_b16 v[112:113], v8 offset:0
    ds_read_b64_tr_b16 v[114:115], v8 offset:1536
    ds_read_b64_tr_b16 v[116:117], v8 offset:64
    ds_read_b64_tr_b16 v[118:119], v8 offset:1600
    ds_read_b64_tr_b16 v[120:121], v8 offset:128
    ds_read_b64_tr_b16 v[122:123], v8 offset:1664
    s_waitcnt vmcnt(0)
    v_sub_f32 v142, 1.0, v140
    v_cvt_pk_bf16_f32 v142, v142, v142
    v_lshlrev_b32 v142, 16, v142
    v_lshlrev_b32 v12, 16, v128
    v_lshlrev_b32 v143, 16, v130
    v_add_f32 v12, v12, v143
    v_lshlrev_b32 v143, 16, v132
    v_add_f32 v12, v12, v143
    v_mul_f32 v12, v142, v12
    v_and_b32 v13, 0xffff0000, v128
    v_and_b32 v143, 0xffff0000, v130
    v_add_f32 v13, v13, v143
    v_and_b32 v143, 0xffff0000, v132
    v_add_f32 v13, v13, v143
    v_mul_f32 v13, v142, v13
    v_lshlrev_b32 v14, 16, v129
    v_lshlrev_b32 v143, 16, v131
    v_add_f32 v14, v14, v143
    v_lshlrev_b32 v143, 16, v133
    v_add_f32 v14, v14, v143
    v_mul_f32 v14, v142, v14
    v_and_b32 v15, 0xffff0000, v129
    v_and_b32 v143, 0xffff0000, v131
    v_add_f32 v15, v15, v143
    v_and_b32 v143, 0xffff0000, v133
    v_add_f32 v15, v15, v143
    v_mul_f32 v15, v142, v15
    v_sub_f32 v142, 1.0, v141
    v_cvt_pk_bf16_f32 v142, v142, v142
    v_lshlrev_b32 v142, 16, v142
    v_lshlrev_b32 v16, 16, v134
    v_lshlrev_b32 v143, 16, v136
    v_add_f32 v16, v16, v143
    v_lshlrev_b32 v143, 16, v138
    v_add_f32 v16, v16, v143
    v_mul_f32 v16, v142, v16
    v_and_b32 v17, 0xffff0000, v134
    v_and_b32 v143, 0xffff0000, v136
    v_add_f32 v17, v17, v143
    v_and_b32 v143, 0xffff0000, v138
    v_add_f32 v17, v17, v143
    v_mul_f32 v17, v142, v17
    v_lshlrev_b32 v18, 16, v135
    v_lshlrev_b32 v143, 16, v137
    v_add_f32 v18, v18, v143
    v_lshlrev_b32 v143, 16, v139
    v_add_f32 v18, v18, v143
    v_mul_f32 v18, v142, v18
    v_and_b32 v19, 0xffff0000, v135
    v_and_b32 v143, 0xffff0000, v137
    v_add_f32 v19, v19, v143
    v_and_b32 v143, 0xffff0000, v139
    v_add_f32 v19, v19, v143
    v_mul_f32 v19, v142, v19
    s_cmp_ge_u32 s22, 8
    s_cbranch_scc1 gated_mix__grouped_kv_mqa__geglu_ffn__prompt_kernel_p3r
gated_mix__grouped_kv_mqa__geglu_ffn__prompt_kernel_p3w:
    ds_read_b32 v10, v22 offset:8
    s_waitcnt lgkmcnt(0)
    v_readfirstlane_b32 s47, v10
    s_and_b32 s47, s47, s45
    s_cmp_eq_u32 s47, s45
    s_cbranch_scc1 gated_mix__grouped_kv_mqa__geglu_ffn__prompt_kernel_p3m
    s_sleep 1
    s_branch gated_mix__grouped_kv_mqa__geglu_ffn__prompt_kernel_p3w
gated_mix__grouped_kv_mqa__geglu_ffn__prompt_kernel_p3m:
    buffer_load_dwordx2 v[24:25], v7, s[8:11], s36 offen offset:0 sc1
    buffer_load_dwordx2 v[26:27], v7, s[8:11], s36 offen offset:512 sc1
    buffer_load_dwordx2 v[28:29], v7, s[8:11], s36 offen offset:1024 sc1
    buffer_load_dwordx2 v[30:31], v7, s[8:11], s36 offen offset:1536 sc1
    buffer_load_dwordx2 v[32:33], v7, s[8:11], s36 offen offset:2048 sc1
    buffer_load_dwordx2 v[34:35], v7, s[8:11], s36 offen offset:2560 sc1
    buffer_load_dwordx2 v[36:37], v7, s[8:11], s36 offen offset:3072 sc1
    buffer_load_dwordx2 v[38:39], v7, s[8:11], s36 offen offset:3584 sc1
    buffer_load_dwordx2 v[40:41], v7, s[8:11], s37 offen offset:0 sc1
    buffer_load_dwordx2 v[42:43], v7, s[8:11], s37 offen offset:512 sc1
    buffer_load_dwordx2 v[44:45], v7, s[8:11], s37 offen offset:1024 sc1
    buffer_load_dwordx2 v[46:47], v7, s[8:11], s37 offen offset:1536 sc1
    buffer_load_dwordx2 v[48:49], v7, s[8:11], s37 offen offset:2048 sc1
    buffer_load_dwordx2 v[50:51], v7, s[8:11], s37 offen offset:2560 sc1
    buffer_load_dwordx2 v[52:53], v7, s[8:11], s37 offen offset:3072 sc1
    buffer_load_dwordx2 v[54:55], v7, s[8:11], s37 offen offset:3584 sc1
    buffer_load_dwordx2 v[56:57], v7, s[8:11], s38 offen offset:0 sc1
    buffer_load_dwordx2 v[58:59], v7, s[8:11], s38 offen offset:512 sc1
    buffer_load_dwordx2 v[60:61], v7, s[8:11], s38 offen offset:1024 sc1
    buffer_load_dwordx2 v[62:63], v7, s[8:11], s38 offen offset:1536 sc1
    s_waitcnt vmcnt(18) lgkmcnt(0)
    v_mfma_f32_32x32x16_bf16 v[64:79], v[112:115], v[24:27], v[64:79]
    ds_read_b64_tr_b16 v[144:145], v8 offset:3072
    ds_read_b64_tr_b16 v[146:147], v8 offset:4608
    v_mfma_f32_32x32x16_bf16 v[80:95], v[116:119], v[24:27], v[80:95]
    ds_read_b64_tr_b16 v[148:149], v8 offset:3136
    ds_read_b64_tr_b16 v[150:151], v8 offset:4672
    v_mfma_f32_32x32x16_bf16 v[96:111], v[120:123], v[24:27], v[96:111]
    ds_read_b64_tr_b16 v[152:153], v8 offset:3200
    ds_read_b64_tr_b16 v[154:155], v8 offset:4736
    s_waitcnt vmcnt(16) lgkmcnt(0)
    v_mfma_f32_32x32x16_bf16 v[64:79], v[144:147], v[28:31], v[64:79]
    ds_read_b64_tr_b16 v[112:113], v8 offset:6144
    ds_read_b64_tr_b16 v[114:115], v8 offset:7680
    v_mfma_f32_32x32x16_bf16 v[80:95], v[148:151], v[28:31], v[80:95]
    ds_read_b64_tr_b16 v[116:117], v8 offset:6208
    ds_read_b64_tr_b16 v[118:119], v8 offset:7744
    v_mfma_f32_32x32x16_bf16 v[96:111], v[152:155], v[28:31], v[96:111]
    ds_read_b64_tr_b16 v[120:121], v8 offset:6272
    ds_read_b64_tr_b16 v[122:123], v8 offset:7808
    s_waitcnt vmcnt(14) lgkmcnt(0)
    v_mfma_f32_32x32x16_bf16 v[64:79], v[112:115], v[32:35], v[64:79]
    ds_read_b64_tr_b16 v[144:145], v8 offset:9216
    ds_read_b64_tr_b16 v[146:147], v8 offset:10752
    v_mfma_f32_32x32x16_bf16 v[80:95], v[116:119], v[32:35], v[80:95]
    ds_read_b64_tr_b16 v[148:149], v8 offset:9280
    ds_read_b64_tr_b16 v[150:151], v8 offset:10816
    v_mfma_f32_32x32x16_bf16 v[96:111], v[120:123], v[32:35], v[96:111]
    ds_read_b64_tr_b16 v[152:153], v8 offset:9344
    ds_read_b64_tr_b16 v[154:155], v8 offset:10880
    s_waitcnt vmcnt(12) lgkmcnt(0)
    v_mfma_f32_32x32x16_bf16 v[64:79], v[144:147], v[36:39], v[64:79]
    ds_read_b64_tr_b16 v[112:113], v8 offset:12288
    ds_read_b64_tr_b16 v[114:115], v8 offset:13824
    v_mfma_f32_32x32x16_bf16 v[80:95], v[148:151], v[36:39], v[80:95]
    ds_read_b64_tr_b16 v[116:117], v8 offset:12352
    ds_read_b64_tr_b16 v[118:119], v8 offset:13888
    v_mfma_f32_32x32x16_bf16 v[96:111], v[152:155], v[36:39], v[96:111]
    ds_read_b64_tr_b16 v[120:121], v8 offset:12416
    ds_read_b64_tr_b16 v[122:123], v8 offset:13952
    s_waitcnt vmcnt(10) lgkmcnt(0)
    v_mfma_f32_32x32x16_bf16 v[64:79], v[112:115], v[40:43], v[64:79]
    ds_read_b64_tr_b16 v[144:145], v8 offset:15360
    ds_read_b64_tr_b16 v[146:147], v8 offset:16896
    v_mfma_f32_32x32x16_bf16 v[80:95], v[116:119], v[40:43], v[80:95]
    ds_read_b64_tr_b16 v[148:149], v8 offset:15424
    ds_read_b64_tr_b16 v[150:151], v8 offset:16960
    v_mfma_f32_32x32x16_bf16 v[96:111], v[120:123], v[40:43], v[96:111]
    ds_read_b64_tr_b16 v[152:153], v8 offset:15488
    ds_read_b64_tr_b16 v[154:155], v8 offset:17024
    s_waitcnt vmcnt(8) lgkmcnt(0)
    v_mfma_f32_32x32x16_bf16 v[64:79], v[144:147], v[44:47], v[64:79]
    ds_read_b64_tr_b16 v[112:113], v8 offset:18432
    ds_read_b64_tr_b16 v[114:115], v8 offset:19968
    v_mfma_f32_32x32x16_bf16 v[80:95], v[148:151], v[44:47], v[80:95]
    ds_read_b64_tr_b16 v[116:117], v8 offset:18496
    ds_read_b64_tr_b16 v[118:119], v8 offset:20032
    v_mfma_f32_32x32x16_bf16 v[96:111], v[152:155], v[44:47], v[96:111]
    ds_read_b64_tr_b16 v[120:121], v8 offset:18560
    ds_read_b64_tr_b16 v[122:123], v8 offset:20096
    s_waitcnt vmcnt(6) lgkmcnt(0)
    v_mfma_f32_32x32x16_bf16 v[64:79], v[112:115], v[48:51], v[64:79]
    ds_read_b64_tr_b16 v[144:145], v8 offset:21504
    ds_read_b64_tr_b16 v[146:147], v8 offset:23040
    v_mfma_f32_32x32x16_bf16 v[80:95], v[116:119], v[48:51], v[80:95]
    ds_read_b64_tr_b16 v[148:149], v8 offset:21568
    ds_read_b64_tr_b16 v[150:151], v8 offset:23104
    v_mfma_f32_32x32x16_bf16 v[96:111], v[120:123], v[48:51], v[96:111]
    ds_read_b64_tr_b16 v[152:153], v8 offset:21632
    ds_read_b64_tr_b16 v[154:155], v8 offset:23168
    s_waitcnt vmcnt(4) lgkmcnt(0)
    v_mfma_f32_32x32x16_bf16 v[64:79], v[144:147], v[52:55], v[64:79]
    ds_read_b64_tr_b16 v[112:113], v8 offset:24576
    ds_read_b64_tr_b16 v[114:115], v8 offset:26112
    v_mfma_f32_32x32x16_bf16 v[80:95], v[148:151], v[52:55], v[80:95]
    ds_read_b64_tr_b16 v[116:117], v8 offset:24640
    ds_read_b64_tr_b16 v[118:119], v8 offset:26176
    v_mfma_f32_32x32x16_bf16 v[96:111], v[152:155], v[52:55], v[96:111]
    ds_read_b64_tr_b16 v[120:121], v8 offset:24704
    ds_read_b64_tr_b16 v[122:123], v8 offset:26240
    s_waitcnt vmcnt(2) lgkmcnt(0)
    v_mfma_f32_32x32x16_bf16 v[64:79], v[112:115], v[56:59], v[64:79]
    ds_read_b64_tr_b16 v[144:145], v8 offset:27648
    ds_read_b64_tr_b16 v[146:147], v8 offset:29184
    v_mfma_f32_32x32x16_bf16 v[80:95], v[116:119], v[56:59], v[80:95]
    ds_read_b64_tr_b16 v[148:149], v8 offset:27712
    ds_read_b64_tr_b16 v[150:151], v8 offset:29248
    v_mfma_f32_32x32x16_bf16 v[96:111], v[120:123], v[56:59], v[96:111]
    ds_read_b64_tr_b16 v[152:153], v8 offset:27776
    ds_read_b64_tr_b16 v[154:155], v8 offset:29312
    s_waitcnt vmcnt(0) lgkmcnt(0)
    v_mfma_f32_32x32x16_bf16 v[64:79], v[144:147], v[60:63], v[64:79]
    v_mfma_f32_32x32x16_bf16 v[80:95], v[148:151], v[60:63], v[80:95]
    v_mfma_f32_32x32x16_bf16 v[96:111], v[152:155], v[60:63], v[96:111]
    v_add_u32 v23, s48, v22
    v_mov_b32 v9, 1
    s_mov_b64 exec, 1
    ds_add_u32 v23, v9 offset:16
    s_mov_b64 exec, -1
    s_and_b32 s47, s22, 1
    s_mul_i32 s47, s47, 10240
    s_add_u32 s39, s49, s47
    v_add_u32 v5, s39, v2
gated_mix__grouped_kv_mqa__geglu_ffn__prompt_kernel_p3pw:
    ds_read_b32 v9, v23 offset:16
    s_waitcnt lgkmcnt(0)
    v_readfirstlane_b32 s47, v9
    s_cmp_lg_u32 s47, 2
    s_cbranch_scc1 gated_mix__grouped_kv_mqa__geglu_ffn__prompt_kernel_p3pw
    ds_write_b128 v5, v[64:67] offset:0
    ds_write_b128 v5, v[68:71] offset:1024
    ds_write_b128 v5, v[72:75] offset:2048
    ds_write_b128 v5, v[76:79] offset:3072
    ds_write_b128 v5, v[80:83] offset:4096
    ds_write_b128 v5, v[84:87] offset:5120
    ds_write_b128 v5, v[88:91] offset:6144
    ds_write_b128 v5, v[92:95] offset:7168
    ds_write_b128 v5, v[96:99] offset:8192
    ds_write_b128 v5, v[100:103] offset:9216
    s_waitcnt lgkmcnt(0)
gated_mix__grouped_kv_mqa__geglu_ffn__prompt_kernel_p3r:
    s_lshl_b32 s39, s22, 10
    v_add_u32 v5, s39, v2
    v_add_u32 v7, 61440, v5
    s_barrier
    ds_read_b128 v[24:27], v5 offset:0
    ds_read_b128 v[28:31], v5 offset:30720
    ds_read_b128 v[32:35], v7 offset:0
    ds_read_b128 v[36:39], v7 offset:30720
    ds_read_b128 v[40:43], v5 offset:10240
    ds_read_b128 v[44:47], v5 offset:40960
    ds_read_b128 v[48:51], v7 offset:10240
    ds_read_b128 v[52:55], v7 offset:40960
    s_waitcnt lgkmcnt(4)
    v_add_f32 v24, v24, v28
    v_add_f32 v32, v32, v36
    v_add_f32 v24, v24, v32
    v_fma_f32 v24, v140, v24, v12
    v_add_f32 v25, v25, v29
    v_add_f32 v33, v33, v37
    v_add_f32 v25, v25, v33
    v_fma_f32 v25, v140, v25, v13
    v_add_f32 v26, v26, v30
    v_add_f32 v34, v34, v38
    v_add_f32 v26, v26, v34
    v_fma_f32 v26, v140, v26, v14
    v_add_f32 v27, v27, v31
    v_add_f32 v35, v35, v39
    v_add_f32 v27, v27, v35
    v_fma_f32 v27, v140, v27, v15
    v_cvt_pk_bf16_f32 v24, v24, v25
    v_cvt_pk_bf16_f32 v25, v26, v27
    buffer_store_dwordx2 v[24:25], v6, s[12:15], s41 offen
    s_waitcnt lgkmcnt(0)
    v_add_f32 v40, v40, v44
    v_add_f32 v48, v48, v52
    v_add_f32 v40, v40, v48
    v_fma_f32 v40, v141, v40, v16
    v_add_f32 v41, v41, v45
    v_add_f32 v49, v49, v53
    v_add_f32 v41, v41, v49
    v_fma_f32 v41, v141, v41, v17
    v_add_f32 v42, v42, v46
    v_add_f32 v50, v50, v54
    v_add_f32 v42, v42, v50
    v_fma_f32 v42, v141, v42, v18
    v_add_f32 v43, v43, v47
    v_add_f32 v51, v51, v55
    v_add_f32 v43, v43, v51
    v_fma_f32 v43, v141, v43, v19
    v_cvt_pk_bf16_f32 v40, v40, v41
    v_cvt_pk_bf16_f32 v41, v42, v43
    buffer_store_dwordx2 v[40:41], v6, s[12:15], s44 offen
gated_mix__grouped_kv_mqa__geglu_ffn__prompt_kernel_end:
    s_endpgm
.section .rodata,"a"
.p2align 6
.amdhsa_kernel gated_mix__grouped_kv_mqa__geglu_ffn__prompt_kernel
  .amdhsa_next_free_vgpr 160
  .amdhsa_next_free_sgpr 100
  .amdhsa_accum_offset 160
  .amdhsa_group_segment_fixed_size 0
  .amdhsa_kernarg_size 104
  .amdhsa_user_sgpr_count 2
  .amdhsa_user_sgpr_kernarg_segment_ptr 1
  .amdhsa_system_sgpr_workgroup_id_x 1
.end_amdhsa_kernel
```
